```python
import torch

def _softmax(x, axis=-1):
    return torch.softmax(x, dim=axis)
def _gelu(x):
    return torch.nn.functional.gelu(x, approximate="tanh")
def _silu(x):
    return torch.nn.functional.silu(x)
def _sigmoid(x):
    return torch.sigmoid(x)
def _layernorm(x, axis=-1, eps=1e-5):
    m = x.mean(dim=axis, keepdim=True)
    v = x.var(dim=axis, keepdim=True, unbiased=False)
    return (x - m) / torch.sqrt(v + eps)
def _scatter_add(tgt, idx, src, axis=0):
    return tgt.clone().index_add_(axis, idx, src)
def _segment_sum(src, seg, n):
    out = torch.zeros((n,) + src.shape[1:], dtype=src.dtype)
    return out.index_add_(0, seg, src)
def _pad(x, pw):
    flat = tuple(v for pair in reversed(pw) for v in pair)
    return torch.nn.functional.pad(x, flat)

kernel_name = 'sequential_preLN__mha_block__mixer_channel_mlp__prompt'

def setup_inputs():

    _w = (lambda a: (lambda t: t.to(torch.bfloat16) if t.is_floating_point() else t)(torch.as_tensor(a)))
    def _A_setup():
        B, S, D, H = 1, 2048, 512, 32
        return {
            "x": _w((lambda *s: torch.randn(*s, dtype=torch.bfloat16) * 0.05)(B, S, D)),
            "wqkv": _w((lambda *s: torch.randn(*s, dtype=torch.bfloat16) * 0.05)(D, 3 * D)),
            "wo": _w((lambda *s: torch.randn(*s, dtype=torch.bfloat16) * 0.05)(D, D)),
        }
    _A_in = _A_setup()

    def _B_setup():
        B, S, D, F = 1, 2048, 512, 1792
        return {
            "x": _w((lambda *s: torch.randn(*s, dtype=torch.bfloat16) * 0.05)(B, S, D)),
            "w1": _w((lambda *s: torch.randn(*s, dtype=torch.bfloat16) * 3.2)(D, F) * (D ** -0.5)),
            "b1": _w((lambda *s: torch.randn(*s, dtype=torch.bfloat16) * 1.6)(F)),
            "w2": _w((lambda *s: torch.randn(*s, dtype=torch.bfloat16) * 0.05)(F, D) * (F ** -0.5)),
            "b2": _w((lambda *s: torch.randn(*s, dtype=torch.bfloat16) * 0.1)(D)),
        }
    _B_in = _B_setup()

    return {
        "A_x": _A_in["x"],
        "A_wqkv": _A_in["wqkv"],
        "A_wo": _A_in["wo"],
        "B_x": _B_in["x"],
        "B_w1": _B_in["w1"],
        "B_b1": _B_in["b1"],
        "B_w2": _B_in["w2"],
        "B_b2": _B_in["b2"],
    }

def reference(A_x, A_wqkv, A_wo, B_x, B_w1, B_b1, B_w2, B_b2):
    def _A_ref(x, wqkv, wo):
        B, S, D = x.shape
        H = 32
        Dh = D // H
        qkv = (lambda x, *d: x.permute(*d))((x @ wqkv).reshape(B, S, 3, H, Dh), 2, 0, 3, 1, 4)
        q, k, v = qkv[0], qkv[1], qkv[2]
        scores = torch.einsum("bhqd,bhkd->bhqk", q, k) * (Dh ** -0.5)
        p = _softmax(scores, axis=-1)
        o = torch.einsum("bhqk,bhkd->bhqd", p, v)
        return (lambda x, *d: x.permute(*d))(o, 0, 2, 1, 3).reshape(B, S, D) @ wo

    def _B_ref(x, w1, b1, w2, b2):
        y = _layernorm(x, axis=-1)
        h = _gelu(torch.einsum("bsd,df->bsf", y, w1) + b1)
        return torch.einsum("bsf,fd->bsd", h, w2) + b2

    x = A_x
    h = x + _A_ref(_layernorm(x, axis=-1), A_wqkv, A_wo)
    h2 = h + _B_ref(_layernorm(h, axis=-1), B_w1, B_b1, B_w2, B_b2)
    return h2
```

```asm
; @launch kernel=qkv_kernel grid=(256,1,1) block=(1024,1,1) lds=163840
; @launch kernel=att_kernel grid=(256,1,1) block=(1024,1,1) lds=153600
; @launch kernel=wo_kernel grid=(256,1,1) block=(768,1,1) lds=131328
; @launch kernel=mlp1_kernel grid=(224,1,1) block=(768,1,1) lds=134144
; @launch kernel=mlp2_kernel grid=(256,1,1) block=(768,1,1) lds=131328
.amdgcn_target "amdgcn-amd-amdhsa--gfx950"
.text
.globl qkv_kernel
.p2align 8
.type qkv_kernel,@function
qkv_kernel:
    s_cmp_ge_u32 s2, 256
    s_cbranch_scc1 qkv_kernel_done
    s_load_dwordx4 s[4:7], s[0:1], 0
    s_load_dwordx2 s[16:17], s[0:1], 80
    s_and_b32 s24, s2, 7
    s_lshr_b32 s25, s2, 3
    s_lshr_b32 s20, s24, 1
    s_lshl_b32 s20, s20, 2
    s_and_b32 s26, s25, 3
    s_add_u32 s20, s20, s26
    s_and_b32 s21, s24, 1
    s_lshl_b32 s21, s21, 3
    s_lshr_b32 s27, s25, 2
    s_add_u32 s21, s21, s27
    s_lshl_b32 s26, s26, 1
    s_add_u32 s29, s26, s27
    s_and_b32 s29, s29, 7
    s_mov_b32 s29, 0
    v_lshrrev_b32 v2, 6, v0
    v_and_b32 v1, 63, v0
    v_readfirstlane_b32 s22, v2
    s_nop 3
    s_add_u32 s36, s22, 4
    s_sub_u32 s37, s22, 8
    s_cmp_lt_u32 s22, 8
    s_cselect_b32 s36, s36, s37
    s_cmp_ge_u32 s22, 12
    s_cselect_b32 s22, s22, s36
    s_lshl_b32 s30, s20, 17
    s_mul_i32 s32, s21, 192
    s_cmp_lt_u32 s22, 4
    s_cbranch_scc1 qkv_kernel_cons
    s_cmp_ge_u32 s22, 12
    s_cbranch_scc1 qkv_kernel_help
    s_cmp_ge_u32 s22, 8
    s_cbranch_scc1 qkv_kernel_wprod
    s_sub_u32 s23, s22, 4
    v_lshrrev_b32 v6, 3, v1
    v_and_b32 v7, 7, v1
    v_lshrrev_b32 v8, 1, v6
    v_add_u32 v8, 0, v8
    v_and_b32 v8, 7, v8
    v_xor_b32 v8, v8, v7
    v_lshlrev_b32 v8, 4, v8
    v_lshl_add_u32 v10, v6, 10, v8
    v_lshrrev_b32 v8, 1, v6
    v_add_u32 v8, 4, v8
    v_and_b32 v8, 7, v8
    v_xor_b32 v8, v8, v7
    v_lshlrev_b32 v8, 4, v8
    v_lshl_add_u32 v11, v6, 10, v8
    v_lshrrev_b32 v8, 1, v6
    v_add_u32 v8, 8, v8
    v_and_b32 v8, 7, v8
    v_xor_b32 v8, v8, v7
    v_lshlrev_b32 v8, 4, v8
    v_lshl_add_u32 v12, v6, 10, v8
    v_lshrrev_b32 v8, 1, v6
    v_add_u32 v8, 12, v8
    v_and_b32 v8, 7, v8
    v_xor_b32 v8, v8, v7
    v_lshlrev_b32 v8, 4, v8
    v_lshl_add_u32 v13, v6, 10, v8
    s_lshl_b32 s34, s23, 15
    s_add_u32 s34, s34, s30
    s_mul_i32 s35, s23, 4096
    s_mul_i32 s38, s29, 128
    s_add_u32 s34, s34, s38
    s_sub_u32 s38, 8, s29
    s_waitcnt lgkmcnt(0)
    s_mov_b32 s8, s4
    s_mov_b32 s9, s5
    s_mov_b32 s10, 2097152
    s_mov_b32 s11, 0x00020000
    s_add_u32 m0, s35, 0
    s_nop 0
    buffer_load_dwordx4 v10, s[8:11], s34 offen lds
    s_add_u32 m0, s35, 1024
    s_add_u32 s26, s34, 8192
    buffer_load_dwordx4 v11, s[8:11], s26 offen lds
    s_add_u32 m0, s35, 2048
    s_add_u32 s26, s34, 16384
    buffer_load_dwordx4 v12, s[8:11], s26 offen lds
    s_add_u32 m0, s35, 3072
    s_add_u32 s26, s34, 24576
    buffer_load_dwordx4 v13, s[8:11], s26 offen lds
    s_add_u32 s34, s34, 128
    s_sub_u32 s38, s38, 1
    s_cmp_eq_u32 s38, 0
    s_cselect_b32 s26, 1024, 0
    s_sub_u32 s34, s34, s26
    s_add_u32 m0, s35, 28672
    s_nop 0
    buffer_load_dwordx4 v10, s[8:11], s34 offen lds
    s_add_u32 m0, s35, 29696
    s_add_u32 s26, s34, 8192
    buffer_load_dwordx4 v11, s[8:11], s26 offen lds
    s_add_u32 m0, s35, 30720
    s_add_u32 s26, s34, 16384
    buffer_load_dwordx4 v12, s[8:11], s26 offen lds
    s_add_u32 m0, s35, 31744
    s_add_u32 s26, s34, 24576
    buffer_load_dwordx4 v13, s[8:11], s26 offen lds
    s_add_u32 s34, s34, 128
    s_sub_u32 s38, s38, 1
    s_cmp_eq_u32 s38, 0
    s_cselect_b32 s26, 1024, 0
    s_sub_u32 s34, s34, s26
    s_waitcnt vmcnt(4)
    s_barrier
    s_add_u32 m0, s35, 57344
    s_nop 0
    buffer_load_dwordx4 v10, s[8:11], s34 offen lds
    s_add_u32 m0, s35, 58368
    s_add_u32 s26, s34, 8192
    buffer_load_dwordx4 v11, s[8:11], s26 offen lds
    s_add_u32 m0, s35, 59392
    s_add_u32 s26, s34, 16384
    buffer_load_dwordx4 v12, s[8:11], s26 offen lds
    s_add_u32 m0, s35, 60416
    s_add_u32 s26, s34, 24576
    buffer_load_dwordx4 v13, s[8:11], s26 offen lds
    s_add_u32 s34, s34, 128
    s_sub_u32 s38, s38, 1
    s_cmp_eq_u32 s38, 0
    s_cselect_b32 s26, 1024, 0
    s_sub_u32 s34, s34, s26
    s_waitcnt vmcnt(4)
    s_barrier
    s_add_u32 m0, s35, 86016
    s_nop 0
    buffer_load_dwordx4 v10, s[8:11], s34 offen lds
    s_add_u32 m0, s35, 87040
    s_add_u32 s26, s34, 8192
    buffer_load_dwordx4 v11, s[8:11], s26 offen lds
    s_add_u32 m0, s35, 88064
    s_add_u32 s26, s34, 16384
    buffer_load_dwordx4 v12, s[8:11], s26 offen lds
    s_add_u32 m0, s35, 89088
    s_add_u32 s26, s34, 24576
    buffer_load_dwordx4 v13, s[8:11], s26 offen lds
    s_add_u32 s34, s34, 128
    s_sub_u32 s38, s38, 1
    s_cmp_eq_u32 s38, 0
    s_cselect_b32 s26, 1024, 0
    s_sub_u32 s34, s34, s26
    s_waitcnt vmcnt(4)
    s_barrier
    s_add_u32 m0, s35, 114688
    s_nop 0
    buffer_load_dwordx4 v10, s[8:11], s34 offen lds
    s_add_u32 m0, s35, 115712
    s_add_u32 s26, s34, 8192
    buffer_load_dwordx4 v11, s[8:11], s26 offen lds
    s_add_u32 m0, s35, 116736
    s_add_u32 s26, s34, 16384
    buffer_load_dwordx4 v12, s[8:11], s26 offen lds
    s_add_u32 m0, s35, 117760
    s_add_u32 s26, s34, 24576
    buffer_load_dwordx4 v13, s[8:11], s26 offen lds
    s_add_u32 s34, s34, 128
    s_sub_u32 s38, s38, 1
    s_cmp_eq_u32 s38, 0
    s_cselect_b32 s26, 1024, 0
    s_sub_u32 s34, s34, s26
    s_waitcnt vmcnt(4)
    s_barrier
    s_add_u32 m0, s35, 0
    s_nop 0
    buffer_load_dwordx4 v10, s[8:11], s34 offen lds
    s_add_u32 m0, s35, 1024
    s_add_u32 s26, s34, 8192
    buffer_load_dwordx4 v11, s[8:11], s26 offen lds
    s_add_u32 m0, s35, 2048
    s_add_u32 s26, s34, 16384
    buffer_load_dwordx4 v12, s[8:11], s26 offen lds
    s_add_u32 m0, s35, 3072
    s_add_u32 s26, s34, 24576
    buffer_load_dwordx4 v13, s[8:11], s26 offen lds
    s_add_u32 s34, s34, 128
    s_sub_u32 s38, s38, 1
    s_cmp_eq_u32 s38, 0
    s_cselect_b32 s26, 1024, 0
    s_sub_u32 s34, s34, s26
    s_waitcnt vmcnt(4)
    s_barrier
    s_add_u32 m0, s35, 28672
    s_nop 0
    buffer_load_dwordx4 v10, s[8:11], s34 offen lds
    s_add_u32 m0, s35, 29696
    s_add_u32 s26, s34, 8192
    buffer_load_dwordx4 v11, s[8:11], s26 offen lds
    s_add_u32 m0, s35, 30720
    s_add_u32 s26, s34, 16384
    buffer_load_dwordx4 v12, s[8:11], s26 offen lds
    s_add_u32 m0, s35, 31744
    s_add_u32 s26, s34, 24576
    buffer_load_dwordx4 v13, s[8:11], s26 offen lds
    s_add_u32 s34, s34, 128
    s_sub_u32 s38, s38, 1
    s_cmp_eq_u32 s38, 0
    s_cselect_b32 s26, 1024, 0
    s_sub_u32 s34, s34, s26
    s_waitcnt vmcnt(4)
    s_barrier
    s_add_u32 m0, s35, 57344
    s_nop 0
    buffer_load_dwordx4 v10, s[8:11], s34 offen lds
    s_add_u32 m0, s35, 58368
    s_add_u32 s26, s34, 8192
    buffer_load_dwordx4 v11, s[8:11], s26 offen lds
    s_add_u32 m0, s35, 59392
    s_add_u32 s26, s34, 16384
    buffer_load_dwordx4 v12, s[8:11], s26 offen lds
    s_add_u32 m0, s35, 60416
    s_add_u32 s26, s34, 24576
    buffer_load_dwordx4 v13, s[8:11], s26 offen lds
    s_add_u32 s34, s34, 128
    s_sub_u32 s38, s38, 1
    s_cmp_eq_u32 s38, 0
    s_cselect_b32 s26, 1024, 0
    s_sub_u32 s34, s34, s26
    s_waitcnt vmcnt(4)
    s_barrier
    s_waitcnt vmcnt(0)
    s_barrier
    s_endpgm
qkv_kernel_wprod:
    s_sub_u32 s23, s22, 8
    s_mov_b32 s26, 3072
    s_mov_b32 s27, 0x15555556
    v_add_u32 v4, 0, v1
    v_mul_hi_u32 v5, v4, s27
    v_mul_u32_u24 v6, 12, v5
    v_sub_u32 v4, v4, v6
    v_mul_lo_u32 v5, v5, s26
    v_lshl_add_u32 v14, v4, 4, v5
    v_add_u32 v4, 64, v1
    v_mul_hi_u32 v5, v4, s27
    v_mul_u32_u24 v6, 12, v5
    v_sub_u32 v4, v4, v6
    v_mul_lo_u32 v5, v5, s26
    v_lshl_add_u32 v15, v4, 4, v5
    v_add_u32 v4, 128, v1
    v_mul_hi_u32 v5, v4, s27
    v_mul_u32_u24 v6, 12, v5
    v_sub_u32 v4, v4, v6
    v_mul_lo_u32 v5, v5, s26
    v_lshl_add_u32 v16, v4, 4, v5
    s_mul_i32 s36, s23, 49152
    s_add_u32 s36, s36, s32
    s_mul_i32 s37, s23, 3072
    s_add_u32 s37, s37, 16384
    s_mul_i32 s39, s29, 196608
    s_add_u32 s36, s36, s39
    s_sub_u32 s38, 8, s29
    s_waitcnt lgkmcnt(0)
    s_mov_b32 s12, s6
    s_mov_b32 s13, s7
    s_mov_b32 s14, 1572864
    s_mov_b32 s15, 0x00020000
    s_add_u32 m0, s37, 0
    s_nop 0
    buffer_load_dwordx4 v14, s[12:15], s36 offen lds
    s_add_u32 m0, s37, 1024
    s_nop 0
    buffer_load_dwordx4 v15, s[12:15], s36 offen lds
    s_add_u32 m0, s37, 2048
    s_nop 0
    buffer_load_dwordx4 v16, s[12:15], s36 offen lds
    s_add_u32 s36, s36, 196608
    s_sub_u32 s38, s38, 1
    s_cmp_eq_u32 s38, 0
    s_cselect_b32 s27, 1572864, 0
    s_sub_u32 s36, s36, s27
    s_add_u32 m0, s37, 28672
    s_nop 0
    buffer_load_dwordx4 v14, s[12:15], s36 offen lds
    s_add_u32 m0, s37, 29696
    s_nop 0
    buffer_load_dwordx4 v15, s[12:15], s36 offen lds
    s_add_u32 m0, s37, 30720
    s_nop 0
    buffer_load_dwordx4 v16, s[12:15], s36 offen lds
    s_add_u32 s36, s36, 196608
    s_sub_u32 s38, s38, 1
    s_cmp_eq_u32 s38, 0
    s_cselect_b32 s27, 1572864, 0
    s_sub_u32 s36, s36, s27
    s_waitcnt vmcnt(3)
    s_barrier
    s_add_u32 m0, s37, 57344
    s_nop 0
    buffer_load_dwordx4 v14, s[12:15], s36 offen lds
    s_add_u32 m0, s37, 58368
    s_nop 0
    buffer_load_dwordx4 v15, s[12:15], s36 offen lds
    s_add_u32 m0, s37, 59392
    s_nop 0
    buffer_load_dwordx4 v16, s[12:15], s36 offen lds
    s_add_u32 s36, s36, 196608
    s_sub_u32 s38, s38, 1
    s_cmp_eq_u32 s38, 0
    s_cselect_b32 s27, 1572864, 0
    s_sub_u32 s36, s36, s27
    s_waitcnt vmcnt(3)
    s_barrier
    s_add_u32 m0, s37, 86016
    s_nop 0
    buffer_load_dwordx4 v14, s[12:15], s36 offen lds
    s_add_u32 m0, s37, 87040
    s_nop 0
    buffer_load_dwordx4 v15, s[12:15], s36 offen lds
    s_add_u32 m0, s37, 88064
    s_nop 0
    buffer_load_dwordx4 v16, s[12:15], s36 offen lds
    s_add_u32 s36, s36, 196608
    s_sub_u32 s38, s38, 1
    s_cmp_eq_u32 s38, 0
    s_cselect_b32 s27, 1572864, 0
    s_sub_u32 s36, s36, s27
    s_waitcnt vmcnt(3)
    s_barrier
    s_add_u32 m0, s37, 114688
    s_nop 0
    buffer_load_dwordx4 v14, s[12:15], s36 offen lds
    s_add_u32 m0, s37, 115712
    s_nop 0
    buffer_load_dwordx4 v15, s[12:15], s36 offen lds
    s_add_u32 m0, s37, 116736
    s_nop 0
    buffer_load_dwordx4 v16, s[12:15], s36 offen lds
    s_add_u32 s36, s36, 196608
    s_sub_u32 s38, s38, 1
    s_cmp_eq_u32 s38, 0
    s_cselect_b32 s27, 1572864, 0
    s_sub_u32 s36, s36, s27
    s_waitcnt vmcnt(3)
    s_barrier
    s_add_u32 m0, s37, 0
    s_nop 0
    buffer_load_dwordx4 v14, s[12:15], s36 offen lds
    s_add_u32 m0, s37, 1024
    s_nop 0
    buffer_load_dwordx4 v15, s[12:15], s36 offen lds
    s_add_u32 m0, s37, 2048
    s_nop 0
    buffer_load_dwordx4 v16, s[12:15], s36 offen lds
    s_add_u32 s36, s36, 196608
    s_sub_u32 s38, s38, 1
    s_cmp_eq_u32 s38, 0
    s_cselect_b32 s27, 1572864, 0
    s_sub_u32 s36, s36, s27
    s_waitcnt vmcnt(3)
    s_barrier
    s_add_u32 m0, s37, 28672
    s_nop 0
    buffer_load_dwordx4 v14, s[12:15], s36 offen lds
    s_add_u32 m0, s37, 29696
    s_nop 0
    buffer_load_dwordx4 v15, s[12:15], s36 offen lds
    s_add_u32 m0, s37, 30720
    s_nop 0
    buffer_load_dwordx4 v16, s[12:15], s36 offen lds
    s_add_u32 s36, s36, 196608
    s_sub_u32 s38, s38, 1
    s_cmp_eq_u32 s38, 0
    s_cselect_b32 s27, 1572864, 0
    s_sub_u32 s36, s36, s27
    s_waitcnt vmcnt(3)
    s_barrier
    s_add_u32 m0, s37, 57344
    s_nop 0
    buffer_load_dwordx4 v14, s[12:15], s36 offen lds
    s_add_u32 m0, s37, 58368
    s_nop 0
    buffer_load_dwordx4 v15, s[12:15], s36 offen lds
    s_add_u32 m0, s37, 59392
    s_nop 0
    buffer_load_dwordx4 v16, s[12:15], s36 offen lds
    s_add_u32 s36, s36, 196608
    s_sub_u32 s38, s38, 1
    s_cmp_eq_u32 s38, 0
    s_cselect_b32 s27, 1572864, 0
    s_sub_u32 s36, s36, s27
    s_waitcnt vmcnt(3)
    s_barrier
    s_waitcnt vmcnt(0)
    s_barrier
    s_endpgm
qkv_kernel_help:
    s_sub_u32 s23, s22, 12
    s_cmp_lg_u32 s25, 0
    s_cbranch_scc1 qkv_kernel_pcs1
    s_cmp_lg_u32 s22, 12
    s_cbranch_scc1 qkv_kernel_pcs1
    s_getpc_b64 s[80:81]
qkv_kernel_pc2:
    s_add_u32 s80, s80, att_kernel-qkv_kernel_pc2
    s_addc_u32 s81, s81, 0
    v_lshlrev_b32 v107, 7, v1
    v_min_u32 v107, att_kernel_end-att_kernel-4, v107
    v_mov_b32 v105, s81
    v_add_co_u32 v104, vcc, s80, v107
    s_nop 1
    v_addc_co_u32 v105, vcc, 0, v105, vcc
    global_load_dword v106, v[104:105], off
    v_lshlrev_b32 v107, 7, v1
    v_add_u32 v107, 8192, v107
    v_min_u32 v107, att_kernel_end-att_kernel-4, v107
    v_mov_b32 v105, s81
    v_add_co_u32 v104, vcc, s80, v107
    s_nop 1
    v_addc_co_u32 v105, vcc, 0, v105, vcc
    global_load_dword v106, v[104:105], off
qkv_kernel_pcs1:
    v_lshrrev_b32 v4, 5, v1
    v_and_b32 v5, 31, v1
    v_bfe_u32 v6, v1, 1, 3
    v_xor_b32 v6, v6, v4
    v_lshlrev_b32 v6, 4, v6
    v_lshl_add_u32 v6, v5, 7, v6
    s_lshl_b32 s26, s23, 12
    v_add_u32 v20, s26, v6
    v_xor_b32 v21, 32, v20
    v_xor_b32 v22, 64, v20
    v_xor_b32 v23, 96, v20
    v_add_u32 v24, 0x10000, v20
    v_add_u32 v25, 0x10000, v21
    v_add_u32 v26, 0x10000, v22
    v_add_u32 v27, 0x10000, v23
    v_mov_b32 v28, 0
    v_mov_b32 v29, 0
    v_mov_b32 v30, 0
    v_mov_b32 v31, 0
    s_barrier
    ds_read_b128 v[32:35], v20 offset:0
    ds_read_b128 v[36:39], v21 offset:0
    ds_read_b128 v[40:43], v22 offset:0
    ds_read_b128 v[44:47], v23 offset:0
    s_waitcnt lgkmcnt(0)
    s_barrier
    ds_read_b128 v[48:51], v20 offset:28672
    ds_read_b128 v[52:55], v21 offset:28672
    ds_read_b128 v[56:59], v22 offset:28672
    ds_read_b128 v[60:63], v23 offset:28672
    v_lshlrev_b32 v64, 16, v32
    v_and_b32 v65, 0xffff0000, v32
    v_add_f32 v28, v28, v64
    v_add_f32 v29, v29, v65
    v_fmac_f32 v30, v64, v64
    v_fmac_f32 v31, v65, v65
    v_lshlrev_b32 v66, 16, v33
    v_and_b32 v67, 0xffff0000, v33
    v_add_f32 v28, v28, v66
    v_add_f32 v29, v29, v67
    v_fmac_f32 v30, v66, v66
    v_fmac_f32 v31, v67, v67
    v_lshlrev_b32 v64, 16, v34
    v_and_b32 v65, 0xffff0000, v34
    v_add_f32 v28, v28, v64
    v_add_f32 v29, v29, v65
    v_fmac_f32 v30, v64, v64
    v_fmac_f32 v31, v65, v65
    v_lshlrev_b32 v66, 16, v35
    v_and_b32 v67, 0xffff0000, v35
    v_add_f32 v28, v28, v66
    v_add_f32 v29, v29, v67
    v_fmac_f32 v30, v66, v66
    v_fmac_f32 v31, v67, v67
    v_lshlrev_b32 v64, 16, v36
    v_and_b32 v65, 0xffff0000, v36
    v_add_f32 v28, v28, v64
    v_add_f32 v29, v29, v65
    v_fmac_f32 v30, v64, v64
    v_fmac_f32 v31, v65, v65
    v_lshlrev_b32 v66, 16, v37
    v_and_b32 v67, 0xffff0000, v37
    v_add_f32 v28, v28, v66
    v_add_f32 v29, v29, v67
    v_fmac_f32 v30, v66, v66
    v_fmac_f32 v31, v67, v67
    v_lshlrev_b32 v64, 16, v38
    v_and_b32 v65, 0xffff0000, v38
    v_add_f32 v28, v28, v64
    v_add_f32 v29, v29, v65
    v_fmac_f32 v30, v64, v64
    v_fmac_f32 v31, v65, v65
    v_lshlrev_b32 v66, 16, v39
    v_and_b32 v67, 0xffff0000, v39
    v_add_f32 v28, v28, v66
    v_add_f32 v29, v29, v67
    v_fmac_f32 v30, v66, v66
    v_fmac_f32 v31, v67, v67
    v_lshlrev_b32 v64, 16, v40
    v_and_b32 v65, 0xffff0000, v40
    v_add_f32 v28, v28, v64
    v_add_f32 v29, v29, v65
    v_fmac_f32 v30, v64, v64
    v_fmac_f32 v31, v65, v65
    v_lshlrev_b32 v66, 16, v41
    v_and_b32 v67, 0xffff0000, v41
    v_add_f32 v28, v28, v66
    v_add_f32 v29, v29, v67
    v_fmac_f32 v30, v66, v66
    v_fmac_f32 v31, v67, v67
    v_lshlrev_b32 v64, 16, v42
    v_and_b32 v65, 0xffff0000, v42
    v_add_f32 v28, v28, v64
    v_add_f32 v29, v29, v65
    v_fmac_f32 v30, v64, v64
    v_fmac_f32 v31, v65, v65
    v_lshlrev_b32 v66, 16, v43
    v_and_b32 v67, 0xffff0000, v43
    v_add_f32 v28, v28, v66
    v_add_f32 v29, v29, v67
    v_fmac_f32 v30, v66, v66
    v_fmac_f32 v31, v67, v67
    v_lshlrev_b32 v64, 16, v44
    v_and_b32 v65, 0xffff0000, v44
    v_add_f32 v28, v28, v64
    v_add_f32 v29, v29, v65
    v_fmac_f32 v30, v64, v64
    v_fmac_f32 v31, v65, v65
    v_lshlrev_b32 v66, 16, v45
    v_and_b32 v67, 0xffff0000, v45
    v_add_f32 v28, v28, v66
    v_add_f32 v29, v29, v67
    v_fmac_f32 v30, v66, v66
    v_fmac_f32 v31, v67, v67
    v_lshlrev_b32 v64, 16, v46
    v_and_b32 v65, 0xffff0000, v46
    v_add_f32 v28, v28, v64
    v_add_f32 v29, v29, v65
    v_fmac_f32 v30, v64, v64
    v_fmac_f32 v31, v65, v65
    v_lshlrev_b32 v66, 16, v47
    v_and_b32 v67, 0xffff0000, v47
    v_add_f32 v28, v28, v66
    v_add_f32 v29, v29, v67
    v_fmac_f32 v30, v66, v66
    v_fmac_f32 v31, v67, v67
    s_waitcnt lgkmcnt(0)
    s_barrier
    ds_read_b128 v[32:35], v20 offset:57344
    ds_read_b128 v[36:39], v21 offset:57344
    ds_read_b128 v[40:43], v22 offset:57344
    ds_read_b128 v[44:47], v23 offset:57344
    v_lshlrev_b32 v64, 16, v48
    v_and_b32 v65, 0xffff0000, v48
    v_add_f32 v28, v28, v64
    v_add_f32 v29, v29, v65
    v_fmac_f32 v30, v64, v64
    v_fmac_f32 v31, v65, v65
    v_lshlrev_b32 v66, 16, v49
    v_and_b32 v67, 0xffff0000, v49
    v_add_f32 v28, v28, v66
    v_add_f32 v29, v29, v67
    v_fmac_f32 v30, v66, v66
    v_fmac_f32 v31, v67, v67
    v_lshlrev_b32 v64, 16, v50
    v_and_b32 v65, 0xffff0000, v50
    v_add_f32 v28, v28, v64
    v_add_f32 v29, v29, v65
    v_fmac_f32 v30, v64, v64
    v_fmac_f32 v31, v65, v65
    v_lshlrev_b32 v66, 16, v51
    v_and_b32 v67, 0xffff0000, v51
    v_add_f32 v28, v28, v66
    v_add_f32 v29, v29, v67
    v_fmac_f32 v30, v66, v66
    v_fmac_f32 v31, v67, v67
    v_lshlrev_b32 v64, 16, v52
    v_and_b32 v65, 0xffff0000, v52
    v_add_f32 v28, v28, v64
    v_add_f32 v29, v29, v65
    v_fmac_f32 v30, v64, v64
    v_fmac_f32 v31, v65, v65
    v_lshlrev_b32 v66, 16, v53
    v_and_b32 v67, 0xffff0000, v53
    v_add_f32 v28, v28, v66
    v_add_f32 v29, v29, v67
    v_fmac_f32 v30, v66, v66
    v_fmac_f32 v31, v67, v67
    v_lshlrev_b32 v64, 16, v54
    v_and_b32 v65, 0xffff0000, v54
    v_add_f32 v28, v28, v64
    v_add_f32 v29, v29, v65
    v_fmac_f32 v30, v64, v64
    v_fmac_f32 v31, v65, v65
    v_lshlrev_b32 v66, 16, v55
    v_and_b32 v67, 0xffff0000, v55
    v_add_f32 v28, v28, v66
    v_add_f32 v29, v29, v67
    v_fmac_f32 v30, v66, v66
    v_fmac_f32 v31, v67, v67
    v_lshlrev_b32 v64, 16, v56
    v_and_b32 v65, 0xffff0000, v56
    v_add_f32 v28, v28, v64
    v_add_f32 v29, v29, v65
    v_fmac_f32 v30, v64, v64
    v_fmac_f32 v31, v65, v65
    v_lshlrev_b32 v66, 16, v57
    v_and_b32 v67, 0xffff0000, v57
    v_add_f32 v28, v28, v66
    v_add_f32 v29, v29, v67
    v_fmac_f32 v30, v66, v66
    v_fmac_f32 v31, v67, v67
    v_lshlrev_b32 v64, 16, v58
    v_and_b32 v65, 0xffff0000, v58
    v_add_f32 v28, v28, v64
    v_add_f32 v29, v29, v65
    v_fmac_f32 v30, v64, v64
    v_fmac_f32 v31, v65, v65
    v_lshlrev_b32 v66, 16, v59
    v_and_b32 v67, 0xffff0000, v59
    v_add_f32 v28, v28, v66
    v_add_f32 v29, v29, v67
    v_fmac_f32 v30, v66, v66
    v_fmac_f32 v31, v67, v67
    v_lshlrev_b32 v64, 16, v60
    v_and_b32 v65, 0xffff0000, v60
    v_add_f32 v28, v28, v64
    v_add_f32 v29, v29, v65
    v_fmac_f32 v30, v64, v64
    v_fmac_f32 v31, v65, v65
    v_lshlrev_b32 v66, 16, v61
    v_and_b32 v67, 0xffff0000, v61
    v_add_f32 v28, v28, v66
    v_add_f32 v29, v29, v67
    v_fmac_f32 v30, v66, v66
    v_fmac_f32 v31, v67, v67
    v_lshlrev_b32 v64, 16, v62
    v_and_b32 v65, 0xffff0000, v62
    v_add_f32 v28, v28, v64
    v_add_f32 v29, v29, v65
    v_fmac_f32 v30, v64, v64
    v_fmac_f32 v31, v65, v65
    v_lshlrev_b32 v66, 16, v63
    v_and_b32 v67, 0xffff0000, v63
    v_add_f32 v28, v28, v66
    v_add_f32 v29, v29, v67
    v_fmac_f32 v30, v66, v66
    v_fmac_f32 v31, v67, v67
    s_waitcnt lgkmcnt(0)
    s_barrier
    ds_read_b128 v[48:51], v24 offset:20480
    ds_read_b128 v[52:55], v25 offset:20480
    ds_read_b128 v[56:59], v26 offset:20480
    ds_read_b128 v[60:63], v27 offset:20480
    v_lshlrev_b32 v64, 16, v32
    v_and_b32 v65, 0xffff0000, v32
    v_add_f32 v28, v28, v64
    v_add_f32 v29, v29, v65
    v_fmac_f32 v30, v64, v64
    v_fmac_f32 v31, v65, v65
    v_lshlrev_b32 v66, 16, v33
    v_and_b32 v67, 0xffff0000, v33
    v_add_f32 v28, v28, v66
    v_add_f32 v29, v29, v67
    v_fmac_f32 v30, v66, v66
    v_fmac_f32 v31, v67, v67
    v_lshlrev_b32 v64, 16, v34
    v_and_b32 v65, 0xffff0000, v34
    v_add_f32 v28, v28, v64
    v_add_f32 v29, v29, v65
    v_fmac_f32 v30, v64, v64
    v_fmac_f32 v31, v65, v65
    v_lshlrev_b32 v66, 16, v35
    v_and_b32 v67, 0xffff0000, v35
    v_add_f32 v28, v28, v66
    v_add_f32 v29, v29, v67
    v_fmac_f32 v30, v66, v66
    v_fmac_f32 v31, v67, v67
    v_lshlrev_b32 v64, 16, v36
    v_and_b32 v65, 0xffff0000, v36
    v_add_f32 v28, v28, v64
    v_add_f32 v29, v29, v65
    v_fmac_f32 v30, v64, v64
    v_fmac_f32 v31, v65, v65
    v_lshlrev_b32 v66, 16, v37
    v_and_b32 v67, 0xffff0000, v37
    v_add_f32 v28, v28, v66
    v_add_f32 v29, v29, v67
    v_fmac_f32 v30, v66, v66
    v_fmac_f32 v31, v67, v67
    v_lshlrev_b32 v64, 16, v38
    v_and_b32 v65, 0xffff0000, v38
    v_add_f32 v28, v28, v64
    v_add_f32 v29, v29, v65
    v_fmac_f32 v30, v64, v64
    v_fmac_f32 v31, v65, v65
    v_lshlrev_b32 v66, 16, v39
    v_and_b32 v67, 0xffff0000, v39
    v_add_f32 v28, v28, v66
    v_add_f32 v29, v29, v67
    v_fmac_f32 v30, v66, v66
    v_fmac_f32 v31, v67, v67
    v_lshlrev_b32 v64, 16, v40
    v_and_b32 v65, 0xffff0000, v40
    v_add_f32 v28, v28, v64
    v_add_f32 v29, v29, v65
    v_fmac_f32 v30, v64, v64
    v_fmac_f32 v31, v65, v65
    v_lshlrev_b32 v66, 16, v41
    v_and_b32 v67, 0xffff0000, v41
    v_add_f32 v28, v28, v66
    v_add_f32 v29, v29, v67
    v_fmac_f32 v30, v66, v66
    v_fmac_f32 v31, v67, v67
    v_lshlrev_b32 v64, 16, v42
    v_and_b32 v65, 0xffff0000, v42
    v_add_f32 v28, v28, v64
    v_add_f32 v29, v29, v65
    v_fmac_f32 v30, v64, v64
    v_fmac_f32 v31, v65, v65
    v_lshlrev_b32 v66, 16, v43
    v_and_b32 v67, 0xffff0000, v43
    v_add_f32 v28, v28, v66
    v_add_f32 v29, v29, v67
    v_fmac_f32 v30, v66, v66
    v_fmac_f32 v31, v67, v67
    v_lshlrev_b32 v64, 16, v44
    v_and_b32 v65, 0xffff0000, v44
    v_add_f32 v28, v28, v64
    v_add_f32 v29, v29, v65
    v_fmac_f32 v30, v64, v64
    v_fmac_f32 v31, v65, v65
    v_lshlrev_b32 v66, 16, v45
    v_and_b32 v67, 0xffff0000, v45
    v_add_f32 v28, v28, v66
    v_add_f32 v29, v29, v67
    v_fmac_f32 v30, v66, v66
    v_fmac_f32 v31, v67, v67
    v_lshlrev_b32 v64, 16, v46
    v_and_b32 v65, 0xffff0000, v46
    v_add_f32 v28, v28, v64
    v_add_f32 v29, v29, v65
    v_fmac_f32 v30, v64, v64
    v_fmac_f32 v31, v65, v65
    v_lshlrev_b32 v66, 16, v47
    v_and_b32 v67, 0xffff0000, v47
    v_add_f32 v28, v28, v66
    v_add_f32 v29, v29, v67
    v_fmac_f32 v30, v66, v66
    v_fmac_f32 v31, v67, v67
    s_waitcnt lgkmcnt(0)
    s_barrier
    ds_read_b128 v[32:35], v24 offset:49152
    ds_read_b128 v[36:39], v25 offset:49152
    ds_read_b128 v[40:43], v26 offset:49152
    ds_read_b128 v[44:47], v27 offset:49152
    v_lshlrev_b32 v64, 16, v48
    v_and_b32 v65, 0xffff0000, v48
    v_add_f32 v28, v28, v64
    v_add_f32 v29, v29, v65
    v_fmac_f32 v30, v64, v64
    v_fmac_f32 v31, v65, v65
    v_lshlrev_b32 v66, 16, v49
    v_and_b32 v67, 0xffff0000, v49
    v_add_f32 v28, v28, v66
    v_add_f32 v29, v29, v67
    v_fmac_f32 v30, v66, v66
    v_fmac_f32 v31, v67, v67
    v_lshlrev_b32 v64, 16, v50
    v_and_b32 v65, 0xffff0000, v50
    v_add_f32 v28, v28, v64
    v_add_f32 v29, v29, v65
    v_fmac_f32 v30, v64, v64
    v_fmac_f32 v31, v65, v65
    v_lshlrev_b32 v66, 16, v51
    v_and_b32 v67, 0xffff0000, v51
    v_add_f32 v28, v28, v66
    v_add_f32 v29, v29, v67
    v_fmac_f32 v30, v66, v66
    v_fmac_f32 v31, v67, v67
    v_lshlrev_b32 v64, 16, v52
    v_and_b32 v65, 0xffff0000, v52
    v_add_f32 v28, v28, v64
    v_add_f32 v29, v29, v65
    v_fmac_f32 v30, v64, v64
    v_fmac_f32 v31, v65, v65
    v_lshlrev_b32 v66, 16, v53
    v_and_b32 v67, 0xffff0000, v53
    v_add_f32 v28, v28, v66
    v_add_f32 v29, v29, v67
    v_fmac_f32 v30, v66, v66
    v_fmac_f32 v31, v67, v67
    v_lshlrev_b32 v64, 16, v54
    v_and_b32 v65, 0xffff0000, v54
    v_add_f32 v28, v28, v64
    v_add_f32 v29, v29, v65
    v_fmac_f32 v30, v64, v64
    v_fmac_f32 v31, v65, v65
    v_lshlrev_b32 v66, 16, v55
    v_and_b32 v67, 0xffff0000, v55
    v_add_f32 v28, v28, v66
    v_add_f32 v29, v29, v67
    v_fmac_f32 v30, v66, v66
    v_fmac_f32 v31, v67, v67
    v_lshlrev_b32 v64, 16, v56
    v_and_b32 v65, 0xffff0000, v56
    v_add_f32 v28, v28, v64
    v_add_f32 v29, v29, v65
    v_fmac_f32 v30, v64, v64
    v_fmac_f32 v31, v65, v65
    v_lshlrev_b32 v66, 16, v57
    v_and_b32 v67, 0xffff0000, v57
    v_add_f32 v28, v28, v66
    v_add_f32 v29, v29, v67
    v_fmac_f32 v30, v66, v66
    v_fmac_f32 v31, v67, v67
    v_lshlrev_b32 v64, 16, v58
    v_and_b32 v65, 0xffff0000, v58
    v_add_f32 v28, v28, v64
    v_add_f32 v29, v29, v65
    v_fmac_f32 v30, v64, v64
    v_fmac_f32 v31, v65, v65
    v_lshlrev_b32 v66, 16, v59
    v_and_b32 v67, 0xffff0000, v59
    v_add_f32 v28, v28, v66
    v_add_f32 v29, v29, v67
    v_fmac_f32 v30, v66, v66
    v_fmac_f32 v31, v67, v67
    v_lshlrev_b32 v64, 16, v60
    v_and_b32 v65, 0xffff0000, v60
    v_add_f32 v28, v28, v64
    v_add_f32 v29, v29, v65
    v_fmac_f32 v30, v64, v64
    v_fmac_f32 v31, v65, v65
    v_lshlrev_b32 v66, 16, v61
    v_and_b32 v67, 0xffff0000, v61
    v_add_f32 v28, v28, v66
    v_add_f32 v29, v29, v67
    v_fmac_f32 v30, v66, v66
    v_fmac_f32 v31, v67, v67
    v_lshlrev_b32 v64, 16, v62
    v_and_b32 v65, 0xffff0000, v62
    v_add_f32 v28, v28, v64
    v_add_f32 v29, v29, v65
    v_fmac_f32 v30, v64, v64
    v_fmac_f32 v31, v65, v65
    v_lshlrev_b32 v66, 16, v63
    v_and_b32 v67, 0xffff0000, v63
    v_add_f32 v28, v28, v66
    v_add_f32 v29, v29, v67
    v_fmac_f32 v30, v66, v66
    v_fmac_f32 v31, v67, v67
    s_waitcnt lgkmcnt(0)
    s_barrier
    ds_read_b128 v[48:51], v20 offset:0
    ds_read_b128 v[52:55], v21 offset:0
    ds_read_b128 v[56:59], v22 offset:0
    ds_read_b128 v[60:63], v23 offset:0
    v_lshlrev_b32 v64, 16, v32
    v_and_b32 v65, 0xffff0000, v32
    v_add_f32 v28, v28, v64
    v_add_f32 v29, v29, v65
    v_fmac_f32 v30, v64, v64
    v_fmac_f32 v31, v65, v65
    v_lshlrev_b32 v66, 16, v33
    v_and_b32 v67, 0xffff0000, v33
    v_add_f32 v28, v28, v66
    v_add_f32 v29, v29, v67
    v_fmac_f32 v30, v66, v66
    v_fmac_f32 v31, v67, v67
    v_lshlrev_b32 v64, 16, v34
    v_and_b32 v65, 0xffff0000, v34
    v_add_f32 v28, v28, v64
    v_add_f32 v29, v29, v65
    v_fmac_f32 v30, v64, v64
    v_fmac_f32 v31, v65, v65
    v_lshlrev_b32 v66, 16, v35
    v_and_b32 v67, 0xffff0000, v35
    v_add_f32 v28, v28, v66
    v_add_f32 v29, v29, v67
    v_fmac_f32 v30, v66, v66
    v_fmac_f32 v31, v67, v67
    v_lshlrev_b32 v64, 16, v36
    v_and_b32 v65, 0xffff0000, v36
    v_add_f32 v28, v28, v64
    v_add_f32 v29, v29, v65
    v_fmac_f32 v30, v64, v64
    v_fmac_f32 v31, v65, v65
    v_lshlrev_b32 v66, 16, v37
    v_and_b32 v67, 0xffff0000, v37
    v_add_f32 v28, v28, v66
    v_add_f32 v29, v29, v67
    v_fmac_f32 v30, v66, v66
    v_fmac_f32 v31, v67, v67
    v_lshlrev_b32 v64, 16, v38
    v_and_b32 v65, 0xffff0000, v38
    v_add_f32 v28, v28, v64
    v_add_f32 v29, v29, v65
    v_fmac_f32 v30, v64, v64
    v_fmac_f32 v31, v65, v65
    v_lshlrev_b32 v66, 16, v39
    v_and_b32 v67, 0xffff0000, v39
    v_add_f32 v28, v28, v66
    v_add_f32 v29, v29, v67
    v_fmac_f32 v30, v66, v66
    v_fmac_f32 v31, v67, v67
    v_lshlrev_b32 v64, 16, v40
    v_and_b32 v65, 0xffff0000, v40
    v_add_f32 v28, v28, v64
    v_add_f32 v29, v29, v65
    v_fmac_f32 v30, v64, v64
    v_fmac_f32 v31, v65, v65
    v_lshlrev_b32 v66, 16, v41
    v_and_b32 v67, 0xffff0000, v41
    v_add_f32 v28, v28, v66
    v_add_f32 v29, v29, v67
    v_fmac_f32 v30, v66, v66
    v_fmac_f32 v31, v67, v67
    v_lshlrev_b32 v64, 16, v42
    v_and_b32 v65, 0xffff0000, v42
    v_add_f32 v28, v28, v64
    v_add_f32 v29, v29, v65
    v_fmac_f32 v30, v64, v64
    v_fmac_f32 v31, v65, v65
    v_lshlrev_b32 v66, 16, v43
    v_and_b32 v67, 0xffff0000, v43
    v_add_f32 v28, v28, v66
    v_add_f32 v29, v29, v67
    v_fmac_f32 v30, v66, v66
    v_fmac_f32 v31, v67, v67
    v_lshlrev_b32 v64, 16, v44
    v_and_b32 v65, 0xffff0000, v44
    v_add_f32 v28, v28, v64
    v_add_f32 v29, v29, v65
    v_fmac_f32 v30, v64, v64
    v_fmac_f32 v31, v65, v65
    v_lshlrev_b32 v66, 16, v45
    v_and_b32 v67, 0xffff0000, v45
    v_add_f32 v28, v28, v66
    v_add_f32 v29, v29, v67
    v_fmac_f32 v30, v66, v66
    v_fmac_f32 v31, v67, v67
    v_lshlrev_b32 v64, 16, v46
    v_and_b32 v65, 0xffff0000, v46
    v_add_f32 v28, v28, v64
    v_add_f32 v29, v29, v65
    v_fmac_f32 v30, v64, v64
    v_fmac_f32 v31, v65, v65
    v_lshlrev_b32 v66, 16, v47
    v_and_b32 v67, 0xffff0000, v47
    v_add_f32 v28, v28, v66
    v_add_f32 v29, v29, v67
    v_fmac_f32 v30, v66, v66
    v_fmac_f32 v31, v67, v67
    s_waitcnt lgkmcnt(0)
    s_barrier
    ds_read_b128 v[32:35], v20 offset:28672
    ds_read_b128 v[36:39], v21 offset:28672
    ds_read_b128 v[40:43], v22 offset:28672
    ds_read_b128 v[44:47], v23 offset:28672
    v_lshlrev_b32 v64, 16, v48
    v_and_b32 v65, 0xffff0000, v48
    v_add_f32 v28, v28, v64
    v_add_f32 v29, v29, v65
    v_fmac_f32 v30, v64, v64
    v_fmac_f32 v31, v65, v65
    v_lshlrev_b32 v66, 16, v49
    v_and_b32 v67, 0xffff0000, v49
    v_add_f32 v28, v28, v66
    v_add_f32 v29, v29, v67
    v_fmac_f32 v30, v66, v66
    v_fmac_f32 v31, v67, v67
    v_lshlrev_b32 v64, 16, v50
    v_and_b32 v65, 0xffff0000, v50
    v_add_f32 v28, v28, v64
    v_add_f32 v29, v29, v65
    v_fmac_f32 v30, v64, v64
    v_fmac_f32 v31, v65, v65
    v_lshlrev_b32 v66, 16, v51
    v_and_b32 v67, 0xffff0000, v51
    v_add_f32 v28, v28, v66
    v_add_f32 v29, v29, v67
    v_fmac_f32 v30, v66, v66
    v_fmac_f32 v31, v67, v67
    v_lshlrev_b32 v64, 16, v52
    v_and_b32 v65, 0xffff0000, v52
    v_add_f32 v28, v28, v64
    v_add_f32 v29, v29, v65
    v_fmac_f32 v30, v64, v64
    v_fmac_f32 v31, v65, v65
    v_lshlrev_b32 v66, 16, v53
    v_and_b32 v67, 0xffff0000, v53
    v_add_f32 v28, v28, v66
    v_add_f32 v29, v29, v67
    v_fmac_f32 v30, v66, v66
    v_fmac_f32 v31, v67, v67
    v_lshlrev_b32 v64, 16, v54
    v_and_b32 v65, 0xffff0000, v54
    v_add_f32 v28, v28, v64
    v_add_f32 v29, v29, v65
    v_fmac_f32 v30, v64, v64
    v_fmac_f32 v31, v65, v65
    v_lshlrev_b32 v66, 16, v55
    v_and_b32 v67, 0xffff0000, v55
    v_add_f32 v28, v28, v66
    v_add_f32 v29, v29, v67
    v_fmac_f32 v30, v66, v66
    v_fmac_f32 v31, v67, v67
    v_lshlrev_b32 v64, 16, v56
    v_and_b32 v65, 0xffff0000, v56
    v_add_f32 v28, v28, v64
    v_add_f32 v29, v29, v65
    v_fmac_f32 v30, v64, v64
    v_fmac_f32 v31, v65, v65
    v_lshlrev_b32 v66, 16, v57
    v_and_b32 v67, 0xffff0000, v57
    v_add_f32 v28, v28, v66
    v_add_f32 v29, v29, v67
    v_fmac_f32 v30, v66, v66
    v_fmac_f32 v31, v67, v67
    v_lshlrev_b32 v64, 16, v58
    v_and_b32 v65, 0xffff0000, v58
    v_add_f32 v28, v28, v64
    v_add_f32 v29, v29, v65
    v_fmac_f32 v30, v64, v64
    v_fmac_f32 v31, v65, v65
    v_lshlrev_b32 v66, 16, v59
    v_and_b32 v67, 0xffff0000, v59
    v_add_f32 v28, v28, v66
    v_add_f32 v29, v29, v67
    v_fmac_f32 v30, v66, v66
    v_fmac_f32 v31, v67, v67
    v_lshlrev_b32 v64, 16, v60
    v_and_b32 v65, 0xffff0000, v60
    v_add_f32 v28, v28, v64
    v_add_f32 v29, v29, v65
    v_fmac_f32 v30, v64, v64
    v_fmac_f32 v31, v65, v65
    v_lshlrev_b32 v66, 16, v61
    v_and_b32 v67, 0xffff0000, v61
    v_add_f32 v28, v28, v66
    v_add_f32 v29, v29, v67
    v_fmac_f32 v30, v66, v66
    v_fmac_f32 v31, v67, v67
    v_lshlrev_b32 v64, 16, v62
    v_and_b32 v65, 0xffff0000, v62
    v_add_f32 v28, v28, v64
    v_add_f32 v29, v29, v65
    v_fmac_f32 v30, v64, v64
    v_fmac_f32 v31, v65, v65
    v_lshlrev_b32 v66, 16, v63
    v_and_b32 v67, 0xffff0000, v63
    v_add_f32 v28, v28, v66
    v_add_f32 v29, v29, v67
    v_fmac_f32 v30, v66, v66
    v_fmac_f32 v31, v67, v67
    s_waitcnt lgkmcnt(0)
    s_barrier
    ds_read_b128 v[48:51], v20 offset:57344
    ds_read_b128 v[52:55], v21 offset:57344
    ds_read_b128 v[56:59], v22 offset:57344
    ds_read_b128 v[60:63], v23 offset:57344
    v_lshlrev_b32 v64, 16, v32
    v_and_b32 v65, 0xffff0000, v32
    v_add_f32 v28, v28, v64
    v_add_f32 v29, v29, v65
    v_fmac_f32 v30, v64, v64
    v_fmac_f32 v31, v65, v65
    v_lshlrev_b32 v66, 16, v33
    v_and_b32 v67, 0xffff0000, v33
    v_add_f32 v28, v28, v66
    v_add_f32 v29, v29, v67
    v_fmac_f32 v30, v66, v66
    v_fmac_f32 v31, v67, v67
    v_lshlrev_b32 v64, 16, v34
    v_and_b32 v65, 0xffff0000, v34
    v_add_f32 v28, v28, v64
    v_add_f32 v29, v29, v65
    v_fmac_f32 v30, v64, v64
    v_fmac_f32 v31, v65, v65
    v_lshlrev_b32 v66, 16, v35
    v_and_b32 v67, 0xffff0000, v35
    v_add_f32 v28, v28, v66
    v_add_f32 v29, v29, v67
    v_fmac_f32 v30, v66, v66
    v_fmac_f32 v31, v67, v67
    v_lshlrev_b32 v64, 16, v36
    v_and_b32 v65, 0xffff0000, v36
    v_add_f32 v28, v28, v64
    v_add_f32 v29, v29, v65
    v_fmac_f32 v30, v64, v64
    v_fmac_f32 v31, v65, v65
    v_lshlrev_b32 v66, 16, v37
    v_and_b32 v67, 0xffff0000, v37
    v_add_f32 v28, v28, v66
    v_add_f32 v29, v29, v67
    v_fmac_f32 v30, v66, v66
    v_fmac_f32 v31, v67, v67
    v_lshlrev_b32 v64, 16, v38
    v_and_b32 v65, 0xffff0000, v38
    v_add_f32 v28, v28, v64
    v_add_f32 v29, v29, v65
    v_fmac_f32 v30, v64, v64
    v_fmac_f32 v31, v65, v65
    v_lshlrev_b32 v66, 16, v39
    v_and_b32 v67, 0xffff0000, v39
    v_add_f32 v28, v28, v66
    v_add_f32 v29, v29, v67
    v_fmac_f32 v30, v66, v66
    v_fmac_f32 v31, v67, v67
    v_lshlrev_b32 v64, 16, v40
    v_and_b32 v65, 0xffff0000, v40
    v_add_f32 v28, v28, v64
    v_add_f32 v29, v29, v65
    v_fmac_f32 v30, v64, v64
    v_fmac_f32 v31, v65, v65
    v_lshlrev_b32 v66, 16, v41
    v_and_b32 v67, 0xffff0000, v41
    v_add_f32 v28, v28, v66
    v_add_f32 v29, v29, v67
    v_fmac_f32 v30, v66, v66
    v_fmac_f32 v31, v67, v67
    v_lshlrev_b32 v64, 16, v42
    v_and_b32 v65, 0xffff0000, v42
    v_add_f32 v28, v28, v64
    v_add_f32 v29, v29, v65
    v_fmac_f32 v30, v64, v64
    v_fmac_f32 v31, v65, v65
    v_lshlrev_b32 v66, 16, v43
    v_and_b32 v67, 0xffff0000, v43
    v_add_f32 v28, v28, v66
    v_add_f32 v29, v29, v67
    v_fmac_f32 v30, v66, v66
    v_fmac_f32 v31, v67, v67
    v_lshlrev_b32 v64, 16, v44
    v_and_b32 v65, 0xffff0000, v44
    v_add_f32 v28, v28, v64
    v_add_f32 v29, v29, v65
    v_fmac_f32 v30, v64, v64
    v_fmac_f32 v31, v65, v65
    v_lshlrev_b32 v66, 16, v45
    v_and_b32 v67, 0xffff0000, v45
    v_add_f32 v28, v28, v66
    v_add_f32 v29, v29, v67
    v_fmac_f32 v30, v66, v66
    v_fmac_f32 v31, v67, v67
    v_lshlrev_b32 v64, 16, v46
    v_and_b32 v65, 0xffff0000, v46
    v_add_f32 v28, v28, v64
    v_add_f32 v29, v29, v65
    v_fmac_f32 v30, v64, v64
    v_fmac_f32 v31, v65, v65
    v_lshlrev_b32 v66, 16, v47
    v_and_b32 v67, 0xffff0000, v47
    v_add_f32 v28, v28, v66
    v_add_f32 v29, v29, v67
    v_fmac_f32 v30, v66, v66
    v_fmac_f32 v31, v67, v67
    s_waitcnt lgkmcnt(0)
    v_lshlrev_b32 v64, 16, v48
    v_and_b32 v65, 0xffff0000, v48
    v_add_f32 v28, v28, v64
    v_add_f32 v29, v29, v65
    v_fmac_f32 v30, v64, v64
    v_fmac_f32 v31, v65, v65
    v_lshlrev_b32 v66, 16, v49
    v_and_b32 v67, 0xffff0000, v49
    v_add_f32 v28, v28, v66
    v_add_f32 v29, v29, v67
    v_fmac_f32 v30, v66, v66
    v_fmac_f32 v31, v67, v67
    v_lshlrev_b32 v64, 16, v50
    v_and_b32 v65, 0xffff0000, v50
    v_add_f32 v28, v28, v64
    v_add_f32 v29, v29, v65
    v_fmac_f32 v30, v64, v64
    v_fmac_f32 v31, v65, v65
    v_lshlrev_b32 v66, 16, v51
    v_and_b32 v67, 0xffff0000, v51
    v_add_f32 v28, v28, v66
    v_add_f32 v29, v29, v67
    v_fmac_f32 v30, v66, v66
    v_fmac_f32 v31, v67, v67
    v_lshlrev_b32 v64, 16, v52
    v_and_b32 v65, 0xffff0000, v52
    v_add_f32 v28, v28, v64
    v_add_f32 v29, v29, v65
    v_fmac_f32 v30, v64, v64
    v_fmac_f32 v31, v65, v65
    v_lshlrev_b32 v66, 16, v53
    v_and_b32 v67, 0xffff0000, v53
    v_add_f32 v28, v28, v66
    v_add_f32 v29, v29, v67
    v_fmac_f32 v30, v66, v66
    v_fmac_f32 v31, v67, v67
    v_lshlrev_b32 v64, 16, v54
    v_and_b32 v65, 0xffff0000, v54
    v_add_f32 v28, v28, v64
    v_add_f32 v29, v29, v65
    v_fmac_f32 v30, v64, v64
    v_fmac_f32 v31, v65, v65
    v_lshlrev_b32 v66, 16, v55
    v_and_b32 v67, 0xffff0000, v55
    v_add_f32 v28, v28, v66
    v_add_f32 v29, v29, v67
    v_fmac_f32 v30, v66, v66
    v_fmac_f32 v31, v67, v67
    v_lshlrev_b32 v64, 16, v56
    v_and_b32 v65, 0xffff0000, v56
    v_add_f32 v28, v28, v64
    v_add_f32 v29, v29, v65
    v_fmac_f32 v30, v64, v64
    v_fmac_f32 v31, v65, v65
    v_lshlrev_b32 v66, 16, v57
    v_and_b32 v67, 0xffff0000, v57
    v_add_f32 v28, v28, v66
    v_add_f32 v29, v29, v67
    v_fmac_f32 v30, v66, v66
    v_fmac_f32 v31, v67, v67
    v_lshlrev_b32 v64, 16, v58
    v_and_b32 v65, 0xffff0000, v58
    v_add_f32 v28, v28, v64
    v_add_f32 v29, v29, v65
    v_fmac_f32 v30, v64, v64
    v_fmac_f32 v31, v65, v65
    v_lshlrev_b32 v66, 16, v59
    v_and_b32 v67, 0xffff0000, v59
    v_add_f32 v28, v28, v66
    v_add_f32 v29, v29, v67
    v_fmac_f32 v30, v66, v66
    v_fmac_f32 v31, v67, v67
    v_lshlrev_b32 v64, 16, v60
    v_and_b32 v65, 0xffff0000, v60
    v_add_f32 v28, v28, v64
    v_add_f32 v29, v29, v65
    v_fmac_f32 v30, v64, v64
    v_fmac_f32 v31, v65, v65
    v_lshlrev_b32 v66, 16, v61
    v_and_b32 v67, 0xffff0000, v61
    v_add_f32 v28, v28, v66
    v_add_f32 v29, v29, v67
    v_fmac_f32 v30, v66, v66
    v_fmac_f32 v31, v67, v67
    v_lshlrev_b32 v64, 16, v62
    v_and_b32 v65, 0xffff0000, v62
    v_add_f32 v28, v28, v64
    v_add_f32 v29, v29, v65
    v_fmac_f32 v30, v64, v64
    v_fmac_f32 v31, v65, v65
    v_lshlrev_b32 v66, 16, v63
    v_and_b32 v67, 0xffff0000, v63
    v_add_f32 v28, v28, v66
    v_add_f32 v29, v29, v67
    v_fmac_f32 v30, v66, v66
    v_fmac_f32 v31, v67, v67
    v_add_f32 v28, v28, v29
    v_add_f32 v30, v30, v31
    v_mov_b32 v29, v28
    v_mov_b32 v31, v30
    s_nop 1
    v_permlane32_swap_b32 v28, v29
    v_permlane32_swap_b32 v30, v31
    s_nop 0
    v_add_f32 v28, v28, v29
    v_add_f32 v30, v30, v31
    v_mul_f32 v28, 0x3b000000, v28
    v_mul_f32 v30, 0x3b000000, v30
    v_fma_f32 v30, -v28, v28, v30
    v_max_f32 v30, 0, v30
    v_add_f32 v30, 0x3727c5ac, v30
    v_rsq_f32 v30, v30
    v_lshlrev_b32 v5, 3, v1
    v_mul_f32 v31, v28, v30
    v_sub_f32 v31, 0, v31
    s_lshl_b32 s26, s23, 9
    s_add_u32 s26, s26, 160256
    v_add_u32 v5, s26, v5
    ds_write_b64 v5, v[30:31]
    s_waitcnt lgkmcnt(0)
    s_barrier
    s_endpgm
qkv_kernel_cons:
    s_mov_b32 s23, s22
    s_mov_b32 s24, 0
    v_and_b32 v3, 31, v1
    v_lshrrev_b32 v4, 5, v1
    v_lshlrev_b32 v2, 4, v1
    v_mov_b32 v10, 0x3f803f80
    v_mov_b32 v11, 0x3f803f80
    v_mov_b32 v12, 0x3f803f80
    v_mov_b32 v13, 0x3f803f80
    v_mov_b32 v112, 0
    v_mov_b32 v113, 0
    v_mov_b32 v114, 0
    v_mov_b32 v115, 0
    v_mov_b32 v116, 0
    v_mov_b32 v117, 0
    v_mov_b32 v118, 0
    v_mov_b32 v119, 0
    v_mov_b32 v120, 0
    v_mov_b32 v121, 0
    v_mov_b32 v122, 0
    v_mov_b32 v123, 0
    v_mov_b32 v124, 0
    v_mov_b32 v125, 0
    v_mov_b32 v126, 0
    v_mov_b32 v127, 0
    s_min_u32 s36, s22, 2
    s_waitcnt lgkmcnt(0)
    s_mov_b32 s18, 6291456
    s_mov_b32 s19, 0x00020000
    v_lshrrev_b32 v4, 5, v1
    v_and_b32 v5, 31, v1
    v_bfe_u32 v6, v1, 1, 3
    v_xor_b32 v6, v6, v4
    v_lshlrev_b32 v6, 4, v6
    v_lshl_add_u32 v6, v5, 7, v6
    s_lshl_b32 s26, s23, 12
    v_add_u32 v14, s26, v6
    v_bfe_u32 v7, v1, 2, 2
    v_lshl_add_u32 v8, v4, 3, v7
    v_mul_u32_u24 v8, 192, v8
    v_bfe_u32 v7, v1, 4, 1
    v_lshl_add_u32 v8, v7, 5, v8
    v_and_b32 v7, 3, v1
    v_lshl_add_u32 v8, v7, 3, v8
    v_add_u32 v8, 16384, v8
    s_lshl_b32 s26, s24, 6
    v_add_u32 v15, s26, v8
    v_mov_b32 v16, v14
    v_xor_b32 v17, 32, v14
    v_xor_b32 v18, 64, v14
    v_xor_b32 v19, 96, v14
    v_mov_b32 v20, v15
    v_mov_b32 v21, v16
    v_mov_b32 v22, v17
    v_mov_b32 v23, v18
    v_mov_b32 v24, v19
    v_mov_b32 v25, v20
    v_mov_b32 v64, 0
    v_mov_b32 v65, 0
    v_mov_b32 v66, 0
    v_mov_b32 v67, 0
    v_mov_b32 v68, 0
    v_mov_b32 v69, 0
    v_mov_b32 v70, 0
    v_mov_b32 v71, 0
    v_mov_b32 v72, 0
    v_mov_b32 v73, 0
    v_mov_b32 v74, 0
    v_mov_b32 v75, 0
    v_mov_b32 v76, 0
    v_mov_b32 v77, 0
    v_mov_b32 v78, 0
    v_mov_b32 v79, 0
    v_mov_b32 v80, 0
    v_mov_b32 v81, 0
    v_mov_b32 v82, 0
    v_mov_b32 v83, 0
    v_mov_b32 v84, 0
    v_mov_b32 v85, 0
    v_mov_b32 v86, 0
    v_mov_b32 v87, 0
    v_mov_b32 v88, 0
    v_mov_b32 v89, 0
    v_mov_b32 v90, 0
    v_mov_b32 v91, 0
    v_mov_b32 v92, 0
    v_mov_b32 v93, 0
    v_mov_b32 v94, 0
    v_mov_b32 v95, 0
    v_mov_b32 v96, 0
    v_mov_b32 v97, 0
    v_mov_b32 v98, 0
    v_mov_b32 v99, 0
    v_mov_b32 v100, 0
    v_mov_b32 v101, 0
    v_mov_b32 v102, 0
    v_mov_b32 v103, 0
    v_mov_b32 v104, 0
    v_mov_b32 v105, 0
    v_mov_b32 v106, 0
    v_mov_b32 v107, 0
    v_mov_b32 v108, 0
    v_mov_b32 v109, 0
    v_mov_b32 v110, 0
    v_mov_b32 v111, 0
    s_mov_b32 s34, 0
    s_mov_b32 s35, 0
    s_barrier
    ds_read_b128 v[32:35], v21 offset:0
    ds_read_b64_tr_b16 v[36:37], v25 offset:0
    ds_read_b64_tr_b16 v[38:39], v25 offset:768
    ds_read_b64_tr_b16 v[40:41], v25 offset:64
    ds_read_b64_tr_b16 v[42:43], v25 offset:832
    ds_read_b64_tr_b16 v[44:45], v25 offset:128
    ds_read_b64_tr_b16 v[46:47], v25 offset:896
    ds_read_b128 v[48:51], v22 offset:0
    ds_read_b64_tr_b16 v[52:53], v25 offset:3072
    ds_read_b64_tr_b16 v[54:55], v25 offset:3840
    ds_read_b64_tr_b16 v[56:57], v25 offset:3136
    ds_read_b64_tr_b16 v[58:59], v25 offset:3904
    ds_read_b64_tr_b16 v[60:61], v25 offset:3200
    ds_read_b64_tr_b16 v[62:63], v25 offset:3968
    s_cmp_eq_u32 s36, 1
    s_cbranch_scc1 qkv_kernel_var1
    s_cmp_eq_u32 s36, 2
    s_cbranch_scc1 qkv_kernel_var2
qkv_kernel_var0:
qkv_kernel_loop0:
    s_waitcnt lgkmcnt(7)
    v_mfma_f32_32x32x16_bf16 v[112:127], v[36:39], v[10:13], v[112:127]
    v_mfma_f32_32x32x16_bf16 v[64:79], v[36:39], v[32:35], v[64:79]
    ds_read_b64_tr_b16 v[36:37], v25 offset:6144
    ds_read_b64_tr_b16 v[38:39], v25 offset:6912
    v_mfma_f32_32x32x16_bf16 v[80:95], v[40:43], v[32:35], v[80:95]
    ds_read_b64_tr_b16 v[40:41], v25 offset:6208
    ds_read_b64_tr_b16 v[42:43], v25 offset:6976
    v_mfma_f32_32x32x16_bf16 v[96:111], v[44:47], v[32:35], v[96:111]
    ds_read_b64_tr_b16 v[44:45], v25 offset:6272
    ds_read_b64_tr_b16 v[46:47], v25 offset:7040
    ds_read_b128 v[32:35], v23 offset:0
    s_waitcnt lgkmcnt(7)
    v_mfma_f32_32x32x16_bf16 v[112:127], v[52:55], v[10:13], v[112:127]
    v_mfma_f32_32x32x16_bf16 v[64:79], v[52:55], v[48:51], v[64:79]
    ds_read_b64_tr_b16 v[52:53], v25 offset:9216
    ds_read_b64_tr_b16 v[54:55], v25 offset:9984
    v_mfma_f32_32x32x16_bf16 v[80:95], v[56:59], v[48:51], v[80:95]
    ds_read_b64_tr_b16 v[56:57], v25 offset:9280
    ds_read_b64_tr_b16 v[58:59], v25 offset:10048
    v_mfma_f32_32x32x16_bf16 v[96:111], v[60:63], v[48:51], v[96:111]
    ds_read_b64_tr_b16 v[60:61], v25 offset:9344
    ds_read_b64_tr_b16 v[62:63], v25 offset:10112
    ds_read_b128 v[48:51], v24 offset:0
    s_add_u32 s34, s34, 28672
    s_cmp_eq_u32 s34, 143360
    s_cselect_b32 s34, 0, s34
    v_add_u32 v26, s34, v16
    v_add_u32 v27, s34, v17
    v_add_u32 v28, s34, v18
    v_add_u32 v29, s34, v19
    v_add_u32 v30, s34, v20
    s_barrier
    s_waitcnt lgkmcnt(7)
    v_mfma_f32_32x32x16_bf16 v[112:127], v[36:39], v[10:13], v[112:127]
    v_mfma_f32_32x32x16_bf16 v[64:79], v[36:39], v[32:35], v[64:79]
    ds_read_b64_tr_b16 v[36:37], v30 offset:0
    ds_read_b64_tr_b16 v[38:39], v30 offset:768
    v_mfma_f32_32x32x16_bf16 v[80:95], v[40:43], v[32:35], v[80:95]
    ds_read_b64_tr_b16 v[40:41], v30 offset:64
    ds_read_b64_tr_b16 v[42:43], v30 offset:832
    v_mfma_f32_32x32x16_bf16 v[96:111], v[44:47], v[32:35], v[96:111]
    ds_read_b64_tr_b16 v[44:45], v30 offset:128
    ds_read_b64_tr_b16 v[46:47], v30 offset:896
    ds_read_b128 v[32:35], v26 offset:0
    s_waitcnt lgkmcnt(7)
    v_mfma_f32_32x32x16_bf16 v[112:127], v[52:55], v[10:13], v[112:127]
    v_mfma_f32_32x32x16_bf16 v[64:79], v[52:55], v[48:51], v[64:79]
    ds_read_b64_tr_b16 v[52:53], v30 offset:3072
    ds_read_b64_tr_b16 v[54:55], v30 offset:3840
    v_mfma_f32_32x32x16_bf16 v[80:95], v[56:59], v[48:51], v[80:95]
    ds_read_b64_tr_b16 v[56:57], v30 offset:3136
    ds_read_b64_tr_b16 v[58:59], v30 offset:3904
    v_mfma_f32_32x32x16_bf16 v[96:111], v[60:63], v[48:51], v[96:111]
    ds_read_b64_tr_b16 v[60:61], v30 offset:3200
    ds_read_b64_tr_b16 v[62:63], v30 offset:3968
    ds_read_b128 v[48:51], v27 offset:0
    v_mov_b32 v21, v26
    v_mov_b32 v22, v27
    v_mov_b32 v23, v28
    v_mov_b32 v24, v29
    v_mov_b32 v25, v30
    s_add_u32 s35, s35, 1
    s_cmp_lt_u32 s35, 7
    s_cbranch_scc1 qkv_kernel_loop0
    s_waitcnt lgkmcnt(7)
    v_mfma_f32_32x32x16_bf16 v[112:127], v[36:39], v[10:13], v[112:127]
    v_mfma_f32_32x32x16_bf16 v[64:79], v[36:39], v[32:35], v[64:79]
    ds_read_b64_tr_b16 v[36:37], v25 offset:6144
    ds_read_b64_tr_b16 v[38:39], v25 offset:6912
    v_mfma_f32_32x32x16_bf16 v[80:95], v[40:43], v[32:35], v[80:95]
    ds_read_b64_tr_b16 v[40:41], v25 offset:6208
    ds_read_b64_tr_b16 v[42:43], v25 offset:6976
    v_mfma_f32_32x32x16_bf16 v[96:111], v[44:47], v[32:35], v[96:111]
    ds_read_b64_tr_b16 v[44:45], v25 offset:6272
    ds_read_b64_tr_b16 v[46:47], v25 offset:7040
    ds_read_b128 v[32:35], v23 offset:0
    s_waitcnt lgkmcnt(7)
    v_mfma_f32_32x32x16_bf16 v[112:127], v[52:55], v[10:13], v[112:127]
    v_mfma_f32_32x32x16_bf16 v[64:79], v[52:55], v[48:51], v[64:79]
    ds_read_b64_tr_b16 v[52:53], v25 offset:9216
    ds_read_b64_tr_b16 v[54:55], v25 offset:9984
    v_mfma_f32_32x32x16_bf16 v[80:95], v[56:59], v[48:51], v[80:95]
    ds_read_b64_tr_b16 v[56:57], v25 offset:9280
    ds_read_b64_tr_b16 v[58:59], v25 offset:10048
    v_mfma_f32_32x32x16_bf16 v[96:111], v[60:63], v[48:51], v[96:111]
    ds_read_b64_tr_b16 v[60:61], v25 offset:9344
    ds_read_b64_tr_b16 v[62:63], v25 offset:10112
    ds_read_b128 v[48:51], v24 offset:0
    s_waitcnt lgkmcnt(7)
    v_mfma_f32_32x32x16_bf16 v[112:127], v[36:39], v[10:13], v[112:127]
    v_mfma_f32_32x32x16_bf16 v[64:79], v[36:39], v[32:35], v[64:79]
    v_mfma_f32_32x32x16_bf16 v[80:95], v[40:43], v[32:35], v[80:95]
    v_mfma_f32_32x32x16_bf16 v[96:111], v[44:47], v[32:35], v[96:111]
    s_waitcnt lgkmcnt(0)
    v_mfma_f32_32x32x16_bf16 v[112:127], v[52:55], v[10:13], v[112:127]
    v_mfma_f32_32x32x16_bf16 v[64:79], v[52:55], v[48:51], v[64:79]
    v_mfma_f32_32x32x16_bf16 v[80:95], v[56:59], v[48:51], v[80:95]
    v_mfma_f32_32x32x16_bf16 v[96:111], v[60:63], v[48:51], v[96:111]
    s_branch qkv_kernel_epi
qkv_kernel_var1:
qkv_kernel_loop1:
    s_waitcnt lgkmcnt(7)
    v_mfma_f32_32x32x16_bf16 v[112:127], v[40:43], v[10:13], v[112:127]
    v_mfma_f32_32x32x16_bf16 v[64:79], v[36:39], v[32:35], v[64:79]
    ds_read_b64_tr_b16 v[36:37], v25 offset:6144
    ds_read_b64_tr_b16 v[38:39], v25 offset:6912
    v_mfma_f32_32x32x16_bf16 v[80:95], v[40:43], v[32:35], v[80:95]
    ds_read_b64_tr_b16 v[40:41], v25 offset:6208
    ds_read_b64_tr_b16 v[42:43], v25 offset:6976
    v_mfma_f32_32x32x16_bf16 v[96:111], v[44:47], v[32:35], v[96:111]
    ds_read_b64_tr_b16 v[44:45], v25 offset:6272
    ds_read_b64_tr_b16 v[46:47], v25 offset:7040
    ds_read_b128 v[32:35], v23 offset:0
    s_waitcnt lgkmcnt(7)
    v_mfma_f32_32x32x16_bf16 v[112:127], v[56:59], v[10:13], v[112:127]
    v_mfma_f32_32x32x16_bf16 v[64:79], v[52:55], v[48:51], v[64:79]
    ds_read_b64_tr_b16 v[52:53], v25 offset:9216
    ds_read_b64_tr_b16 v[54:55], v25 offset:9984
    v_mfma_f32_32x32x16_bf16 v[80:95], v[56:59], v[48:51], v[80:95]
    ds_read_b64_tr_b16 v[56:57], v25 offset:9280
    ds_read_b64_tr_b16 v[58:59], v25 offset:10048
    v_mfma_f32_32x32x16_bf16 v[96:111], v[60:63], v[48:51], v[96:111]
    ds_read_b64_tr_b16 v[60:61], v25 offset:9344
    ds_read_b64_tr_b16 v[62:63], v25 offset:10112
    ds_read_b128 v[48:51], v24 offset:0
    s_add_u32 s34, s34, 28672
    s_cmp_eq_u32 s34, 143360
    s_cselect_b32 s34, 0, s34
    v_add_u32 v26, s34, v16
    v_add_u32 v27, s34, v17
    v_add_u32 v28, s34, v18
    v_add_u32 v29, s34, v19
    v_add_u32 v30, s34, v20
    s_barrier
    s_waitcnt lgkmcnt(7)
    v_mfma_f32_32x32x16_bf16 v[112:127], v[40:43], v[10:13], v[112:127]
    v_mfma_f32_32x32x16_bf16 v[64:79], v[36:39], v[32:35], v[64:79]
    ds_read_b64_tr_b16 v[36:37], v30 offset:0
    ds_read_b64_tr_b16 v[38:39], v30 offset:768
    v_mfma_f32_32x32x16_bf16 v[80:95], v[40:43], v[32:35], v[80:95]
    ds_read_b64_tr_b16 v[40:41], v30 offset:64
    ds_read_b64_tr_b16 v[42:43], v30 offset:832
    v_mfma_f32_32x32x16_bf16 v[96:111], v[44:47], v[32:35], v[96:111]
    ds_read_b64_tr_b16 v[44:45], v30 offset:128
    ds_read_b64_tr_b16 v[46:47], v30 offset:896
    ds_read_b128 v[32:35], v26 offset:0
    s_waitcnt lgkmcnt(7)
    v_mfma_f32_32x32x16_bf16 v[112:127], v[56:59], v[10:13], v[112:127]
    v_mfma_f32_32x32x16_bf16 v[64:79], v[52:55], v[48:51], v[64:79]
    ds_read_b64_tr_b16 v[52:53], v30 offset:3072
    ds_read_b64_tr_b16 v[54:55], v30 offset:3840
    v_mfma_f32_32x32x16_bf16 v[80:95], v[56:59], v[48:51], v[80:95]
    ds_read_b64_tr_b16 v[56:57], v30 offset:3136
    ds_read_b64_tr_b16 v[58:59], v30 offset:3904
    v_mfma_f32_32x32x16_bf16 v[96:111], v[60:63], v[48:51], v[96:111]
    ds_read_b64_tr_b16 v[60:61], v30 offset:3200
    ds_read_b64_tr_b16 v[62:63], v30 offset:3968
    ds_read_b128 v[48:51], v27 offset:0
    v_mov_b32 v21, v26
    v_mov_b32 v22, v27
    v_mov_b32 v23, v28
    v_mov_b32 v24, v29
    v_mov_b32 v25, v30
    s_add_u32 s35, s35, 1
    s_cmp_lt_u32 s35, 7
    s_cbranch_scc1 qkv_kernel_loop1
    s_waitcnt lgkmcnt(7)
    v_mfma_f32_32x32x16_bf16 v[112:127], v[40:43], v[10:13], v[112:127]
    v_mfma_f32_32x32x16_bf16 v[64:79], v[36:39], v[32:35], v[64:79]
    ds_read_b64_tr_b16 v[36:37], v25 offset:6144
    ds_read_b64_tr_b16 v[38:39], v25 offset:6912
    v_mfma_f32_32x32x16_bf16 v[80:95], v[40:43], v[32:35], v[80:95]
    ds_read_b64_tr_b16 v[40:41], v25 offset:6208
    ds_read_b64_tr_b16 v[42:43], v25 offset:6976
    v_mfma_f32_32x32x16_bf16 v[96:111], v[44:47], v[32:35], v[96:111]
    ds_read_b64_tr_b16 v[44:45], v25 offset:6272
    ds_read_b64_tr_b16 v[46:47], v25 offset:7040
    ds_read_b128 v[32:35], v23 offset:0
    s_waitcnt lgkmcnt(7)
    v_mfma_f32_32x32x16_bf16 v[112:127], v[56:59], v[10:13], v[112:127]
    v_mfma_f32_32x32x16_bf16 v[64:79], v[52:55], v[48:51], v[64:79]
    ds_read_b64_tr_b16 v[52:53], v25 offset:9216
    ds_read_b64_tr_b16 v[54:55], v25 offset:9984
    v_mfma_f32_32x32x16_bf16 v[80:95], v[56:59], v[48:51], v[80:95]
    ds_read_b64_tr_b16 v[56:57], v25 offset:9280
    ds_read_b64_tr_b16 v[58:59], v25 offset:10048
    v_mfma_f32_32x32x16_bf16 v[96:111], v[60:63], v[48:51], v[96:111]
    ds_read_b64_tr_b16 v[60:61], v25 offset:9344
    ds_read_b64_tr_b16 v[62:63], v25 offset:10112
    ds_read_b128 v[48:51], v24 offset:0
    s_waitcnt lgkmcnt(7)
    v_mfma_f32_32x32x16_bf16 v[112:127], v[40:43], v[10:13], v[112:127]
    v_mfma_f32_32x32x16_bf16 v[64:79], v[36:39], v[32:35], v[64:79]
    v_mfma_f32_32x32x16_bf16 v[80:95], v[40:43], v[32:35], v[80:95]
    v_mfma_f32_32x32x16_bf16 v[96:111], v[44:47], v[32:35], v[96:111]
    s_waitcnt lgkmcnt(0)
    v_mfma_f32_32x32x16_bf16 v[112:127], v[56:59], v[10:13], v[112:127]
    v_mfma_f32_32x32x16_bf16 v[64:79], v[52:55], v[48:51], v[64:79]
    v_mfma_f32_32x32x16_bf16 v[80:95], v[56:59], v[48:51], v[80:95]
    v_mfma_f32_32x32x16_bf16 v[96:111], v[60:63], v[48:51], v[96:111]
    s_branch qkv_kernel_epi
qkv_kernel_var2:
qkv_kernel_loop2:
    s_waitcnt lgkmcnt(7)
    v_mfma_f32_32x32x16_bf16 v[112:127], v[44:47], v[10:13], v[112:127]
    v_mfma_f32_32x32x16_bf16 v[64:79], v[36:39], v[32:35], v[64:79]
    ds_read_b64_tr_b16 v[36:37], v25 offset:6144
    ds_read_b64_tr_b16 v[38:39], v25 offset:6912
    v_mfma_f32_32x32x16_bf16 v[80:95], v[40:43], v[32:35], v[80:95]
    ds_read_b64_tr_b16 v[40:41], v25 offset:6208
    ds_read_b64_tr_b16 v[42:43], v25 offset:6976
    v_mfma_f32_32x32x16_bf16 v[96:111], v[44:47], v[32:35], v[96:111]
    ds_read_b64_tr_b16 v[44:45], v25 offset:6272
    ds_read_b64_tr_b16 v[46:47], v25 offset:7040
    ds_read_b128 v[32:35], v23 offset:0
    s_waitcnt lgkmcnt(7)
    v_mfma_f32_32x32x16_bf16 v[112:127], v[60:63], v[10:13], v[112:127]
    v_mfma_f32_32x32x16_bf16 v[64:79], v[52:55], v[48:51], v[64:79]
    ds_read_b64_tr_b16 v[52:53], v25 offset:9216
    ds_read_b64_tr_b16 v[54:55], v25 offset:9984
    v_mfma_f32_32x32x16_bf16 v[80:95], v[56:59], v[48:51], v[80:95]
    ds_read_b64_tr_b16 v[56:57], v25 offset:9280
    ds_read_b64_tr_b16 v[58:59], v25 offset:10048
    v_mfma_f32_32x32x16_bf16 v[96:111], v[60:63], v[48:51], v[96:111]
    ds_read_b64_tr_b16 v[60:61], v25 offset:9344
    ds_read_b64_tr_b16 v[62:63], v25 offset:10112
    ds_read_b128 v[48:51], v24 offset:0
    s_add_u32 s34, s34, 28672
    s_cmp_eq_u32 s34, 143360
    s_cselect_b32 s34, 0, s34
    v_add_u32 v26, s34, v16
    v_add_u32 v27, s34, v17
    v_add_u32 v28, s34, v18
    v_add_u32 v29, s34, v19
    v_add_u32 v30, s34, v20
    s_barrier
    s_waitcnt lgkmcnt(7)
    v_mfma_f32_32x32x16_bf16 v[112:127], v[44:47], v[10:13], v[112:127]
    v_mfma_f32_32x32x16_bf16 v[64:79], v[36:39], v[32:35], v[64:79]
    ds_read_b64_tr_b16 v[36:37], v30 offset:0
    ds_read_b64_tr_b16 v[38:39], v30 offset:768
    v_mfma_f32_32x32x16_bf16 v[80:95], v[40:43], v[32:35], v[80:95]
    ds_read_b64_tr_b16 v[40:41], v30 offset:64
    ds_read_b64_tr_b16 v[42:43], v30 offset:832
    v_mfma_f32_32x32x16_bf16 v[96:111], v[44:47], v[32:35], v[96:111]
    ds_read_b64_tr_b16 v[44:45], v30 offset:128
    ds_read_b64_tr_b16 v[46:47], v30 offset:896
    ds_read_b128 v[32:35], v26 offset:0
    s_waitcnt lgkmcnt(7)
    v_mfma_f32_32x32x16_bf16 v[112:127], v[60:63], v[10:13], v[112:127]
    v_mfma_f32_32x32x16_bf16 v[64:79], v[52:55], v[48:51], v[64:79]
    ds_read_b64_tr_b16 v[52:53], v30 offset:3072
    ds_read_b64_tr_b16 v[54:55], v30 offset:3840
    v_mfma_f32_32x32x16_bf16 v[80:95], v[56:59], v[48:51], v[80:95]
    ds_read_b64_tr_b16 v[56:57], v30 offset:3136
    ds_read_b64_tr_b16 v[58:59], v30 offset:3904
    v_mfma_f32_32x32x16_bf16 v[96:111], v[60:63], v[48:51], v[96:111]
    ds_read_b64_tr_b16 v[60:61], v30 offset:3200
    ds_read_b64_tr_b16 v[62:63], v30 offset:3968
    ds_read_b128 v[48:51], v27 offset:0
    v_mov_b32 v21, v26
    v_mov_b32 v22, v27
    v_mov_b32 v23, v28
    v_mov_b32 v24, v29
    v_mov_b32 v25, v30
    s_add_u32 s35, s35, 1
    s_cmp_lt_u32 s35, 7
    s_cbranch_scc1 qkv_kernel_loop2
    s_waitcnt lgkmcnt(7)
    v_mfma_f32_32x32x16_bf16 v[112:127], v[44:47], v[10:13], v[112:127]
    v_mfma_f32_32x32x16_bf16 v[64:79], v[36:39], v[32:35], v[64:79]
    ds_read_b64_tr_b16 v[36:37], v25 offset:6144
    ds_read_b64_tr_b16 v[38:39], v25 offset:6912
    v_mfma_f32_32x32x16_bf16 v[80:95], v[40:43], v[32:35], v[80:95]
    ds_read_b64_tr_b16 v[40:41], v25 offset:6208
    ds_read_b64_tr_b16 v[42:43], v25 offset:6976
    v_mfma_f32_32x32x16_bf16 v[96:111], v[44:47], v[32:35], v[96:111]
    ds_read_b64_tr_b16 v[44:45], v25 offset:6272
    ds_read_b64_tr_b16 v[46:47], v25 offset:7040
    ds_read_b128 v[32:35], v23 offset:0
    s_waitcnt lgkmcnt(7)
    v_mfma_f32_32x32x16_bf16 v[112:127], v[60:63], v[10:13], v[112:127]
    v_mfma_f32_32x32x16_bf16 v[64:79], v[52:55], v[48:51], v[64:79]
    ds_read_b64_tr_b16 v[52:53], v25 offset:9216
    ds_read_b64_tr_b16 v[54:55], v25 offset:9984
    v_mfma_f32_32x32x16_bf16 v[80:95], v[56:59], v[48:51], v[80:95]
    ds_read_b64_tr_b16 v[56:57], v25 offset:9280
    ds_read_b64_tr_b16 v[58:59], v25 offset:10048
    v_mfma_f32_32x32x16_bf16 v[96:111], v[60:63], v[48:51], v[96:111]
    ds_read_b64_tr_b16 v[60:61], v25 offset:9344
    ds_read_b64_tr_b16 v[62:63], v25 offset:10112
    ds_read_b128 v[48:51], v24 offset:0
    s_waitcnt lgkmcnt(7)
    v_mfma_f32_32x32x16_bf16 v[112:127], v[44:47], v[10:13], v[112:127]
    v_mfma_f32_32x32x16_bf16 v[64:79], v[36:39], v[32:35], v[64:79]
    v_mfma_f32_32x32x16_bf16 v[80:95], v[40:43], v[32:35], v[80:95]
    v_mfma_f32_32x32x16_bf16 v[96:111], v[44:47], v[32:35], v[96:111]
    s_waitcnt lgkmcnt(0)
    v_mfma_f32_32x32x16_bf16 v[112:127], v[60:63], v[10:13], v[112:127]
    v_mfma_f32_32x32x16_bf16 v[64:79], v[52:55], v[48:51], v[64:79]
    v_mfma_f32_32x32x16_bf16 v[80:95], v[56:59], v[48:51], v[80:95]
    v_mfma_f32_32x32x16_bf16 v[96:111], v[60:63], v[48:51], v[96:111]
qkv_kernel_epi:
    v_lshlrev_b32 v5, 4, v4
    s_lshl_b32 s26, s36, 7
    s_add_u32 s26, s26, 159744
    v_add_u32 v11, s26, v5
    s_mov_b32 exec_lo, 1
    s_mov_b32 exec_hi, 1
    s_nop 4
    ds_write_b128 v11, v[112:115] offset:0
    ds_write_b128 v11, v[116:119] offset:32
    ds_write_b128 v11, v[120:123] offset:64
    ds_write_b128 v11, v[124:127] offset:96
    s_mov_b64 exec, -1
    s_lshl_b32 s27, s20, 2
    s_add_u32 s27, s27, s22
    s_lshl_b32 s27, s27, 10
    s_mul_i32 s28, s21, 3
    s_lshl_b32 s31, s22, 13
    v_mul_u32_u24 v6, 72, v3
    v_lshl_add_u32 v6, v4, 3, v6
    v_add_u32 v6, s31, v6
    v_bfe_u32 v7, v1, 2, 2
    v_lshl_add_u32 v8, v4, 2, v7
    v_mul_u32_u24 v8, 72, v8
    v_bfe_u32 v7, v1, 4, 1
    v_lshl_add_u32 v8, v7, 5, v8
    v_and_b32 v7, 3, v1
    v_lshl_add_u32 v8, v7, 3, v8
    v_add_u32 v8, s31, v8
    v_bfe_u32 v9, v1, 4, 1
    v_lshlrev_b32 v9, 16, v9
    v_lshl_add_u32 v9, v4, 8, v9
    v_and_b32 v7, 15, v1
    v_lshl_add_u32 v9, v7, 4, v9
    v_lshlrev_b32 v5, 4, v4
    v_add_u32 v5, 159744, v5
    v_lshlrev_b32 v10, 3, v1
    s_lshl_b32 s26, s22, 9
    s_add_u32 s26, s26, 160256
    v_add_u32 v10, s26, v10
    s_waitcnt lgkmcnt(0)
    s_barrier
    ds_read_b64 v[12:13], v10
    ds_read_b128 v[16:19], v5 offset:0
    ds_read_b128 v[20:23], v5 offset:32
    ds_read_b128 v[24:27], v5 offset:64
    ds_read_b128 v[28:31], v5 offset:96
    ds_read_b128 v[32:35], v5 offset:128
    ds_read_b128 v[36:39], v5 offset:160
    ds_read_b128 v[40:43], v5 offset:192
    ds_read_b128 v[44:47], v5 offset:224
    ds_read_b128 v[48:51], v5 offset:256
    ds_read_b128 v[52:55], v5 offset:288
    ds_read_b128 v[56:59], v5 offset:320
    ds_read_b128 v[60:63], v5 offset:352
    s_add_u32 s33, s28, 0
    s_waitcnt lgkmcnt(8)
    v_mov_b32 v114, v12
    v_mov_b32 v116, v13
    s_cmp_ge_u32 s33, 16
    s_cbranch_scc1 qkv_kernel_q3
    v_mul_f32 v114, 0x3eb8aa3b, v114
    v_mul_f32 v116, 0x3eb8aa3b, v116
qkv_kernel_q3:
    v_mov_b32 v115, v114
    v_mov_b32 v117, v116
    v_pk_mul_f32 v[16:17], v[16:17], v[116:117]
    v_pk_mul_f32 v[18:19], v[18:19], v[116:117]
    v_pk_mul_f32 v[20:21], v[20:21], v[116:117]
    v_pk_mul_f32 v[22:23], v[22:23], v[116:117]
    v_pk_mul_f32 v[24:25], v[24:25], v[116:117]
    v_pk_mul_f32 v[26:27], v[26:27], v[116:117]
    v_pk_mul_f32 v[28:29], v[28:29], v[116:117]
    v_pk_mul_f32 v[30:31], v[30:31], v[116:117]
    v_pk_fma_f32 v[64:65], v[64:65], v[114:115], v[16:17]
    v_pk_fma_f32 v[66:67], v[66:67], v[114:115], v[18:19]
    v_pk_fma_f32 v[68:69], v[68:69], v[114:115], v[20:21]
    v_pk_fma_f32 v[70:71], v[70:71], v[114:115], v[22:23]
    v_pk_fma_f32 v[72:73], v[72:73], v[114:115], v[24:25]
    v_pk_fma_f32 v[74:75], v[74:75], v[114:115], v[26:27]
    v_pk_fma_f32 v[76:77], v[76:77], v[114:115], v[28:29]
    v_pk_fma_f32 v[78:79], v[78:79], v[114:115], v[30:31]
    v_cvt_pk_bf16_f32 v64, v64, v65
    v_cvt_pk_bf16_f32 v65, v66, v67
    v_cvt_pk_bf16_f32 v66, v68, v69
    v_cvt_pk_bf16_f32 v67, v70, v71
    v_cvt_pk_bf16_f32 v68, v72, v73
    v_cvt_pk_bf16_f32 v69, v74, v75
    v_cvt_pk_bf16_f32 v70, v76, v77
    v_cvt_pk_bf16_f32 v71, v78, v79
    s_lshr_b32 s34, s33, 4
    s_lshl_b32 s34, s34, 21
    s_and_b32 s35, s33, 15
    s_lshl_b32 s35, s35, 17
    s_add_u32 s34, s34, s35
    s_add_u32 s34, s34, s27
    s_mov_b32 s40, s34
    s_cmp_ge_u32 s33, 32
    s_cbranch_scc1 qkv_kernel_v4
    buffer_store_dwordx4 v[64:67], v2, s[16:19], s34 offen sc1
    s_add_u32 s34, s34, 65536
    buffer_store_dwordx4 v[68:71], v2, s[16:19], s34 offen sc1
    s_branch qkv_kernel_e5
qkv_kernel_v4:
    ds_write_b64 v6, v[64:65] offset:0
    ds_write_b64 v6, v[66:67] offset:16
    ds_write_b64 v6, v[68:69] offset:32
    ds_write_b64 v6, v[70:71] offset:48
qkv_kernel_e5:
    s_add_u32 s33, s28, 1
    s_waitcnt lgkmcnt(4)
    v_mov_b32 v114, v12
    v_mov_b32 v116, v13
    s_cmp_ge_u32 s33, 16
    s_cbranch_scc1 qkv_kernel_q6
    v_mul_f32 v114, 0x3eb8aa3b, v114
    v_mul_f32 v116, 0x3eb8aa3b, v116
qkv_kernel_q6:
    v_mov_b32 v115, v114
    v_mov_b32 v117, v116
    v_pk_mul_f32 v[32:33], v[32:33], v[116:117]
    v_pk_mul_f32 v[34:35], v[34:35], v[116:117]
    v_pk_mul_f32 v[36:37], v[36:37], v[116:117]
    v_pk_mul_f32 v[38:39], v[38:39], v[116:117]
    v_pk_mul_f32 v[40:41], v[40:41], v[116:117]
    v_pk_mul_f32 v[42:43], v[42:43], v[116:117]
    v_pk_mul_f32 v[44:45], v[44:45], v[116:117]
    v_pk_mul_f32 v[46:47], v[46:47], v[116:117]
    v_pk_fma_f32 v[80:81], v[80:81], v[114:115], v[32:33]
    v_pk_fma_f32 v[82:83], v[82:83], v[114:115], v[34:35]
    v_pk_fma_f32 v[84:85], v[84:85], v[114:115], v[36:37]
    v_pk_fma_f32 v[86:87], v[86:87], v[114:115], v[38:39]
    v_pk_fma_f32 v[88:89], v[88:89], v[114:115], v[40:41]
    v_pk_fma_f32 v[90:91], v[90:91], v[114:115], v[42:43]
    v_pk_fma_f32 v[92:93], v[92:93], v[114:115], v[44:45]
    v_pk_fma_f32 v[94:95], v[94:95], v[114:115], v[46:47]
    v_cvt_pk_bf16_f32 v80, v80, v81
    v_cvt_pk_bf16_f32 v81, v82, v83
    v_cvt_pk_bf16_f32 v82, v84, v85
    v_cvt_pk_bf16_f32 v83, v86, v87
    v_cvt_pk_bf16_f32 v84, v88, v89
    v_cvt_pk_bf16_f32 v85, v90, v91
    v_cvt_pk_bf16_f32 v86, v92, v93
    v_cvt_pk_bf16_f32 v87, v94, v95
    s_lshr_b32 s34, s33, 4
    s_lshl_b32 s34, s34, 21
    s_and_b32 s35, s33, 15
    s_lshl_b32 s35, s35, 17
    s_add_u32 s34, s34, s35
    s_add_u32 s34, s34, s27
    s_mov_b32 s41, s34
    s_cmp_ge_u32 s33, 32
    s_cbranch_scc1 qkv_kernel_v7
    buffer_store_dwordx4 v[80:83], v2, s[16:19], s34 offen sc1
    s_add_u32 s34, s34, 65536
    buffer_store_dwordx4 v[84:87], v2, s[16:19], s34 offen sc1
    s_branch qkv_kernel_e8
qkv_kernel_v7:
    ds_write_b64 v6, v[80:81] offset:2304
    ds_write_b64 v6, v[82:83] offset:2320
    ds_write_b64 v6, v[84:85] offset:2336
    ds_write_b64 v6, v[86:87] offset:2352
qkv_kernel_e8:
    s_add_u32 s33, s28, 2
    s_waitcnt lgkmcnt(0)
    v_mov_b32 v114, v12
    v_mov_b32 v116, v13
    s_cmp_ge_u32 s33, 16
    s_cbranch_scc1 qkv_kernel_q9
    v_mul_f32 v114, 0x3eb8aa3b, v114
    v_mul_f32 v116, 0x3eb8aa3b, v116
qkv_kernel_q9:
    v_mov_b32 v115, v114
    v_mov_b32 v117, v116
    v_pk_mul_f32 v[48:49], v[48:49], v[116:117]
    v_pk_mul_f32 v[50:51], v[50:51], v[116:117]
    v_pk_mul_f32 v[52:53], v[52:53], v[116:117]
    v_pk_mul_f32 v[54:55], v[54:55], v[116:117]
    v_pk_mul_f32 v[56:57], v[56:57], v[116:117]
    v_pk_mul_f32 v[58:59], v[58:59], v[116:117]
    v_pk_mul_f32 v[60:61], v[60:61], v[116:117]
    v_pk_mul_f32 v[62:63], v[62:63], v[116:117]
    v_pk_fma_f32 v[96:97], v[96:97], v[114:115], v[48:49]
    v_pk_fma_f32 v[98:99], v[98:99], v[114:115], v[50:51]
    v_pk_fma_f32 v[100:101], v[100:101], v[114:115], v[52:53]
    v_pk_fma_f32 v[102:103], v[102:103], v[114:115], v[54:55]
    v_pk_fma_f32 v[104:105], v[104:105], v[114:115], v[56:57]
    v_pk_fma_f32 v[106:107], v[106:107], v[114:115], v[58:59]
    v_pk_fma_f32 v[108:109], v[108:109], v[114:115], v[60:61]
    v_pk_fma_f32 v[110:111], v[110:111], v[114:115], v[62:63]
    v_cvt_pk_bf16_f32 v96, v96, v97
    v_cvt_pk_bf16_f32 v97, v98, v99
    v_cvt_pk_bf16_f32 v98, v100, v101
    v_cvt_pk_bf16_f32 v99, v102, v103
    v_cvt_pk_bf16_f32 v100, v104, v105
    v_cvt_pk_bf16_f32 v101, v106, v107
    v_cvt_pk_bf16_f32 v102, v108, v109
    v_cvt_pk_bf16_f32 v103, v110, v111
    s_lshr_b32 s34, s33, 4
    s_lshl_b32 s34, s34, 21
    s_and_b32 s35, s33, 15
    s_lshl_b32 s35, s35, 17
    s_add_u32 s34, s34, s35
    s_add_u32 s34, s34, s27
    s_mov_b32 s42, s34
    s_cmp_ge_u32 s33, 32
    s_cbranch_scc1 qkv_kernel_v10
    buffer_store_dwordx4 v[96:99], v2, s[16:19], s34 offen sc1
    s_add_u32 s34, s34, 65536
    buffer_store_dwordx4 v[100:103], v2, s[16:19], s34 offen sc1
    s_branch qkv_kernel_e11
qkv_kernel_v10:
    ds_write_b64 v6, v[96:97] offset:4608
    ds_write_b64 v6, v[98:99] offset:4624
    ds_write_b64 v6, v[100:101] offset:4640
    ds_write_b64 v6, v[102:103] offset:4656
qkv_kernel_e11:
    s_add_u32 s33, s28, 2
    s_cmp_lt_u32 s33, 32
    s_cbranch_scc1 qkv_kernel_ve12
    s_waitcnt lgkmcnt(0)
    ds_read_b64_tr_b16 v[72:73], v8 offset:0
    ds_read_b64_tr_b16 v[74:75], v8 offset:576
    ds_read_b64_tr_b16 v[76:77], v8 offset:1152
    ds_read_b64_tr_b16 v[78:79], v8 offset:1728
    ds_read_b64_tr_b16 v[88:89], v8 offset:2304
    ds_read_b64_tr_b16 v[90:91], v8 offset:2880
    ds_read_b64_tr_b16 v[92:93], v8 offset:3456
    ds_read_b64_tr_b16 v[94:95], v8 offset:4032
    ds_read_b64_tr_b16 v[104:105], v8 offset:4608
    ds_read_b64_tr_b16 v[106:107], v8 offset:5184
    ds_read_b64_tr_b16 v[108:109], v8 offset:5760
    ds_read_b64_tr_b16 v[110:111], v8 offset:6336
    s_waitcnt lgkmcnt(8)
    s_add_u32 s33, s28, 0
    s_cmp_lt_u32 s33, 32
    s_cbranch_scc1 qkv_kernel_vs13
    buffer_store_dwordx4 v[72:75], v9, s[16:19], s40 offen sc1
    buffer_store_dwordx4 v[76:79], v9, s[16:19], s40 offen offset:512 sc1
qkv_kernel_vs13:
    s_waitcnt lgkmcnt(4)
    s_add_u32 s33, s28, 1
    s_cmp_lt_u32 s33, 32
    s_cbranch_scc1 qkv_kernel_vs14
    buffer_store_dwordx4 v[88:91], v9, s[16:19], s41 offen sc1
    buffer_store_dwordx4 v[92:95], v9, s[16:19], s41 offen offset:512 sc1
qkv_kernel_vs14:
    s_waitcnt lgkmcnt(0)
    s_add_u32 s33, s28, 2
    s_cmp_lt_u32 s33, 32
    s_cbranch_scc1 qkv_kernel_vs15
    buffer_store_dwordx4 v[104:107], v9, s[16:19], s42 offen sc1
    buffer_store_dwordx4 v[108:111], v9, s[16:19], s42 offen offset:512 sc1
qkv_kernel_vs15:
qkv_kernel_ve12:
qkv_kernel_done:
    s_endpgm
qkv_kernel_end:
.globl att_kernel
.p2align 8
.type att_kernel,@function
att_kernel:
    s_cmp_ge_u32 s2, 256
    s_cbranch_scc1 att_done
    s_load_dwordx2 s[16:17], s[0:1], 80
    s_load_dwordx2 s[44:45], s[0:1], 16
    s_load_dwordx2 s[48:49], s[0:1], 32
    s_load_dwordx2 s[52:53], s[0:1], 48
    s_and_b32 s24, s2, 7
    s_lshr_b32 s25, s2, 3
    s_lshl_b32 s20, s24, 2
    s_and_b32 s26, s25, 3
    s_add_u32 s20, s20, s26
    s_lshr_b32 s21, s25, 2
    v_lshrrev_b32 v2, 6, v0
    v_and_b32 v1, 63, v0
    v_readfirstlane_b32 s22, v2
    v_lshlrev_b32 v2, 4, v1
    s_nop 2
    s_and_b32 s30, s22, 7
    s_lshr_b32 s31, s22, 3
    s_lshl_b32 s23, s20, 16
    s_lshl_b32 s26, s21, 3
    s_add_u32 s27, s26, s30
    s_lshl_b32 s26, s27, 10
    s_add_u32 s39, s26, s23
    s_and_b32 s26, s30, 3
    s_lshl_b32 s26, s26, 10
    s_lshl_b32 s28, s31, 15
    s_add_u32 s26, s26, s28
    s_lshr_b32 s28, s30, 2
    s_lshl_b32 s29, s28, 16
    s_add_u32 s29, s29, s26
    s_lshl_b32 s28, s28, 21
    s_add_u32 s28, s28, 2097152
    s_add_u32 s28, s28, s23
    s_add_u32 s28, s28, s26
    s_waitcnt lgkmcnt(0)
    s_mov_b32 s18, 8388608
    s_mov_b32 s19, 0x00020000
    s_add_u32 s26, s21, 0
    s_and_b32 s26, s26, 7
    s_lshl_b32 s26, s26, 12
    s_add_u32 s26, s26, s28
    s_add_u32 m0, s29, 0
    s_nop 0
    buffer_load_dwordx4 v2, s[16:19], s26 offen lds
    buffer_load_dwordx4 v[4:7], v2, s[16:19], s39 offen
    s_add_u32 s26, s21, 1
    s_and_b32 s26, s26, 7
    s_lshl_b32 s26, s26, 12
    s_add_u32 s26, s26, s28
    s_add_u32 m0, s29, 4096
    s_nop 0
    buffer_load_dwordx4 v2, s[16:19], s26 offen lds
    s_add_u32 s26, s21, 2
    s_and_b32 s26, s26, 7
    s_lshl_b32 s26, s26, 12
    s_add_u32 s26, s26, s28
    s_add_u32 m0, s29, 8192
    s_nop 0
    buffer_load_dwordx4 v2, s[16:19], s26 offen lds
    s_lshl_b32 s26, s31, 15
    v_add_u32 v106, s26, v2
    v_lshrrev_b32 v3, 5, v1
    v_lshlrev_b32 v3, 8, v3
    v_and_b32 v104, 15, v1
    v_lshl_add_u32 v3, v104, 4, v3
    v_add_u32 v3, 0x10000, v3
    v_add_u32 v107, s26, v3
    v_lshlrev_b32 v111, 4, v1
    v_and_b32 v104, 27, v1
    v_cmp_eq_u32 vcc, 16, v104
    v_mov_b32 v105, 0x3f803f80
    v_mov_b32 v104, 0
    v_cndmask_b32 v104, v104, v105, vcc
    v_mov_b32 v16, v104
    v_mov_b32 v17, v104
    v_mov_b32 v18, v104
    v_mov_b32 v19, v104
    v_mov_b32 v20, v104
    v_mov_b32 v21, v104
    v_mov_b32 v22, v104
    v_mov_b32 v23, v104
    v_mov_b32 v24, v104
    v_mov_b32 v25, v104
    v_mov_b32 v26, v104
    v_mov_b32 v27, v104
    v_mov_b32 v28, v104
    v_mov_b32 v29, v104
    v_mov_b32 v30, v104
    v_mov_b32 v31, v104
    s_mov_b32 s34, 0x0000ffff
    s_mov_b32 s35, 0x0000ffff
    s_mov_b32 s36, 0
    s_mov_b32 s37, 1
    s_waitcnt vmcnt(0)
    s_barrier
att_retry:
    v_mov_b32 v104, 0xff800000
    v_mov_b32 v105, v106
    s_mov_b32 s38, 0
att_maxloop:
    ds_read_b128 v[8:11], v105
    v_add_u32 v105, 1024, v105
    s_waitcnt lgkmcnt(0)
    v_mfma_f32_32x32x16_bf16 v[40:55], v[8:11], v[4:7], 0
    s_nop 15
    v_max3_f32 v104, v40, v41, v104
    v_max3_f32 v104, v42, v43, v104
    v_max3_f32 v104, v44, v45, v104
    v_max3_f32 v104, v46, v47, v104
    v_max3_f32 v104, v48, v49, v104
    v_max3_f32 v104, v50, v51, v104
    v_max3_f32 v104, v52, v53, v104
    v_max3_f32 v104, v54, v55, v104
    s_add_u32 s38, s38, 1
    s_cmp_lt_u32 s38, s37
    s_cbranch_scc1 att_maxloop
    v_mov_b32 v105, v104
    s_nop 1
    v_permlane32_swap_b32 v104, v105
    v_mov_b32 v2, v106
    v_mov_b32 v3, v107
    v_max_f32 v104, v104, v105
    ds_read_b128 v[12:15], v2 offset:1024
    s_mov_b64 exec, s[34:35]
    ds_read_b128 v[16:19], v3
    s_mov_b64 exec, -1
    ds_read_b128 v[8:11], v2
    v_sub_f32 v88, 0, v104
    v_sub_f32 v89, 0, v104
    v_sub_f32 v90, 0, v104
    v_sub_f32 v91, 0, v104
    v_sub_f32 v92, 0, v104
    v_sub_f32 v93, 0, v104
    v_sub_f32 v94, 0, v104
    v_sub_f32 v95, 0, v104
    v_sub_f32 v96, 0, v104
    v_sub_f32 v97, 0, v104
    v_sub_f32 v98, 0, v104
    v_sub_f32 v99, 0, v104
    v_sub_f32 v100, 0, v104
    v_sub_f32 v101, 0, v104
    v_sub_f32 v102, 0, v104
    v_sub_f32 v103, 0, v104
    v_mov_b32 v72, 0
    v_mov_b32 v73, 0
    v_mov_b32 v74, 0
    v_mov_b32 v75, 0
    v_mov_b32 v76, 0
    v_mov_b32 v77, 0
    v_mov_b32 v78, 0
    v_mov_b32 v79, 0
    v_mov_b32 v80, 0
    v_mov_b32 v81, 0
    v_mov_b32 v82, 0
    v_mov_b32 v83, 0
    v_mov_b32 v84, 0
    v_mov_b32 v85, 0
    v_mov_b32 v86, 0
    v_mov_b32 v87, 0
    v_mov_b32 v36, 0
    v_mov_b32 v37, 0
    v_mov_b32 v38, 0
    v_mov_b32 v39, 0
    s_waitcnt lgkmcnt(0)
    v_mfma_f32_32x32x16_bf16 v[40:55], v[8:11], v[4:7], v[88:103]
    s_nop 7
    s_mov_b32 s38, 0
    s_cmp_lg_u32 s36, 0
    s_cbranch_scc1 att_loop
    s_setprio 3
    s_waitcnt lgkmcnt(0)
    v_mfma_f32_32x32x16_bf16 v[56:71], v[12:15], v[4:7], v[88:103]
    ds_read_b128 v[8:11], v2 offset:2048
    s_mov_b64 exec, s[34:35]
    ds_read_b128 v[20:23], v3 offset:1024
    ds_read_b128 v[24:27], v3 offset:512
    s_mov_b64 exec, -1
    v_exp_f32 v40, v40
    v_exp_f32 v41, v41
    v_exp_f32 v42, v42
    v_exp_f32 v43, v43
    v_exp_f32 v44, v44
    v_exp_f32 v45, v45
    v_mfma_f32_32x32x16_bf16 v[72:87], v[28:31], v[36:39], v[72:87]
    v_exp_f32 v46, v46
    v_exp_f32 v47, v47
    v_cvt_pk_bf16_f32 v32, v40, v41
    v_cvt_pk_bf16_f32 v33, v42, v43
    v_cvt_pk_bf16_f32 v34, v44, v45
    v_cvt_pk_bf16_f32 v35, v46, v47
    v_exp_f32 v48, v48
    v_exp_f32 v49, v49
    v_exp_f32 v50, v50
    v_mfma_f32_32x32x16_bf16 v[72:87], v[16:19], v[32:35], v[72:87]
    v_exp_f32 v51, v51
    v_exp_f32 v52, v52
    v_exp_f32 v53, v53
    v_exp_f32 v54, v54
    v_exp_f32 v55, v55
    v_cvt_pk_bf16_f32 v36, v48, v49
    v_cvt_pk_bf16_f32 v37, v50, v51
    v_cvt_pk_bf16_f32 v38, v52, v53
    v_cvt_pk_bf16_f32 v39, v54, v55
    s_add_u32 s26, s21, 3
    s_and_b32 s26, s26, 7
    s_lshl_b32 s26, s26, 12
    s_add_u32 s26, s26, s28
    s_add_u32 m0, s29, 12288
    s_nop 0
    buffer_load_dwordx4 v111, s[16:19], s26 offen lds
    s_waitcnt lgkmcnt(0)
    v_mfma_f32_32x32x16_bf16 v[40:55], v[8:11], v[4:7], v[88:103]
    ds_read_b128 v[12:15], v2 offset:3072
    s_mov_b64 exec, s[34:35]
    ds_read_b128 v[16:19], v3 offset:2048
    ds_read_b128 v[28:31], v3 offset:1536
    s_mov_b64 exec, -1
    v_exp_f32 v56, v56
    v_exp_f32 v57, v57
    v_exp_f32 v58, v58
    v_exp_f32 v59, v59
    v_exp_f32 v60, v60
    v_exp_f32 v61, v61
    v_mfma_f32_32x32x16_bf16 v[72:87], v[24:27], v[36:39], v[72:87]
    v_exp_f32 v62, v62
    v_exp_f32 v63, v63
    v_cvt_pk_bf16_f32 v32, v56, v57
    v_cvt_pk_bf16_f32 v33, v58, v59
    v_cvt_pk_bf16_f32 v34, v60, v61
    v_cvt_pk_bf16_f32 v35, v62, v63
    v_exp_f32 v64, v64
    v_exp_f32 v65, v65
    v_exp_f32 v66, v66
    v_mfma_f32_32x32x16_bf16 v[72:87], v[20:23], v[32:35], v[72:87]
    v_exp_f32 v67, v67
    v_exp_f32 v68, v68
    v_exp_f32 v69, v69
    v_exp_f32 v70, v70
    v_exp_f32 v71, v71
    v_cvt_pk_bf16_f32 v36, v64, v65
    v_cvt_pk_bf16_f32 v37, v66, v67
    v_cvt_pk_bf16_f32 v38, v68, v69
    v_cvt_pk_bf16_f32 v39, v70, v71
    s_add_u32 s26, s21, 4
    s_and_b32 s26, s26, 7
    s_lshl_b32 s26, s26, 12
    s_add_u32 s26, s26, s28
    s_add_u32 m0, s29, 16384
    s_nop 0
    buffer_load_dwordx4 v111, s[16:19], s26 offen lds
    s_waitcnt lgkmcnt(0)
    v_mfma_f32_32x32x16_bf16 v[56:71], v[12:15], v[4:7], v[88:103]
    ds_read_b128 v[8:11], v2 offset:4096
    s_mov_b64 exec, s[34:35]
    ds_read_b128 v[20:23], v3 offset:3072
    ds_read_b128 v[24:27], v3 offset:2560
    s_mov_b64 exec, -1
    v_exp_f32 v40, v40
    v_exp_f32 v41, v41
    v_exp_f32 v42, v42
    v_exp_f32 v43, v43
    v_exp_f32 v44, v44
    v_exp_f32 v45, v45
    v_mfma_f32_32x32x16_bf16 v[72:87], v[28:31], v[36:39], v[72:87]
    v_exp_f32 v46, v46
    v_exp_f32 v47, v47
    v_cvt_pk_bf16_f32 v32, v40, v41
    v_cvt_pk_bf16_f32 v33, v42, v43
    v_cvt_pk_bf16_f32 v34, v44, v45
    v_cvt_pk_bf16_f32 v35, v46, v47
    v_exp_f32 v48, v48
    v_exp_f32 v49, v49
    v_exp_f32 v50, v50
    v_mfma_f32_32x32x16_bf16 v[72:87], v[16:19], v[32:35], v[72:87]
    v_exp_f32 v51, v51
    v_exp_f32 v52, v52
    v_exp_f32 v53, v53
    v_exp_f32 v54, v54
    v_exp_f32 v55, v55
    v_cvt_pk_bf16_f32 v36, v48, v49
    v_cvt_pk_bf16_f32 v37, v50, v51
    v_cvt_pk_bf16_f32 v38, v52, v53
    v_cvt_pk_bf16_f32 v39, v54, v55
    s_add_u32 s26, s21, 5
    s_and_b32 s26, s26, 7
    s_lshl_b32 s26, s26, 12
    s_add_u32 s26, s26, s28
    s_add_u32 m0, s29, 20480
    s_nop 0
    buffer_load_dwordx4 v111, s[16:19], s26 offen lds
    s_waitcnt lgkmcnt(0)
    v_mfma_f32_32x32x16_bf16 v[40:55], v[8:11], v[4:7], v[88:103]
    ds_read_b128 v[12:15], v2 offset:5120
    s_mov_b64 exec, s[34:35]
    ds_read_b128 v[16:19], v3 offset:4096
    ds_read_b128 v[28:31], v3 offset:3584
    s_mov_b64 exec, -1
    v_exp_f32 v56, v56
    v_exp_f32 v57, v57
    v_exp_f32 v58, v58
    v_exp_f32 v59, v59
    v_exp_f32 v60, v60
    v_exp_f32 v61, v61
    v_mfma_f32_32x32x16_bf16 v[72:87], v[24:27], v[36:39], v[72:87]
    v_exp_f32 v62, v62
    v_exp_f32 v63, v63
    v_cvt_pk_bf16_f32 v32, v56, v57
    v_cvt_pk_bf16_f32 v33, v58, v59
    v_cvt_pk_bf16_f32 v34, v60, v61
    v_cvt_pk_bf16_f32 v35, v62, v63
    v_exp_f32 v64, v64
    v_exp_f32 v65, v65
    v_exp_f32 v66, v66
    v_mfma_f32_32x32x16_bf16 v[72:87], v[20:23], v[32:35], v[72:87]
    v_exp_f32 v67, v67
    v_exp_f32 v68, v68
    v_exp_f32 v69, v69
    v_exp_f32 v70, v70
    v_exp_f32 v71, v71
    v_cvt_pk_bf16_f32 v36, v64, v65
    v_cvt_pk_bf16_f32 v37, v66, v67
    v_cvt_pk_bf16_f32 v38, v68, v69
    v_cvt_pk_bf16_f32 v39, v70, v71
    s_add_u32 s26, s21, 6
    s_and_b32 s26, s26, 7
    s_lshl_b32 s26, s26, 12
    s_add_u32 s26, s26, s28
    s_add_u32 m0, s29, 24576
    s_nop 0
    buffer_load_dwordx4 v111, s[16:19], s26 offen lds
    s_waitcnt lgkmcnt(0)
    v_mfma_f32_32x32x16_bf16 v[56:71], v[12:15], v[4:7], v[88:103]
    ds_read_b128 v[8:11], v2 offset:6144
    s_mov_b64 exec, s[34:35]
    ds_read_b128 v[20:23], v3 offset:5120
    ds_read_b128 v[24:27], v3 offset:4608
    s_mov_b64 exec, -1
    v_exp_f32 v40, v40
    v_exp_f32 v41, v41
    v_exp_f32 v42, v42
    v_exp_f32 v43, v43
    v_exp_f32 v44, v44
    v_exp_f32 v45, v45
    v_mfma_f32_32x32x16_bf16 v[72:87], v[28:31], v[36:39], v[72:87]
    v_exp_f32 v46, v46
    v_exp_f32 v47, v47
    v_cvt_pk_bf16_f32 v32, v40, v41
    v_cvt_pk_bf16_f32 v33, v42, v43
    v_cvt_pk_bf16_f32 v34, v44, v45
    v_cvt_pk_bf16_f32 v35, v46, v47
    v_exp_f32 v48, v48
    v_exp_f32 v49, v49
    v_exp_f32 v50, v50
    v_mfma_f32_32x32x16_bf16 v[72:87], v[16:19], v[32:35], v[72:87]
    v_exp_f32 v51, v51
    v_exp_f32 v52, v52
    v_exp_f32 v53, v53
    v_exp_f32 v54, v54
    v_exp_f32 v55, v55
    v_cvt_pk_bf16_f32 v36, v48, v49
    v_cvt_pk_bf16_f32 v37, v50, v51
    v_cvt_pk_bf16_f32 v38, v52, v53
    v_cvt_pk_bf16_f32 v39, v54, v55
    s_add_u32 s26, s21, 7
    s_and_b32 s26, s26, 7
    s_lshl_b32 s26, s26, 12
    s_add_u32 s26, s26, s28
    s_add_u32 m0, s29, 28672
    s_nop 0
    buffer_load_dwordx4 v111, s[16:19], s26 offen lds
    s_waitcnt lgkmcnt(0)
    v_mfma_f32_32x32x16_bf16 v[40:55], v[8:11], v[4:7], v[88:103]
    ds_read_b128 v[12:15], v2 offset:7168
    s_mov_b64 exec, s[34:35]
    ds_read_b128 v[16:19], v3 offset:6144
    ds_read_b128 v[28:31], v3 offset:5632
    s_mov_b64 exec, -1
    v_exp_f32 v56, v56
    v_exp_f32 v57, v57
    v_exp_f32 v58, v58
    v_exp_f32 v59, v59
    v_exp_f32 v60, v60
    v_exp_f32 v61, v61
    v_mfma_f32_32x32x16_bf16 v[72:87], v[24:27], v[36:39], v[72:87]
    v_exp_f32 v62, v62
    v_exp_f32 v63, v63
    v_cvt_pk_bf16_f32 v32, v56, v57
    v_cvt_pk_bf16_f32 v33, v58, v59
    v_cvt_pk_bf16_f32 v34, v60, v61
    v_cvt_pk_bf16_f32 v35, v62, v63
    v_exp_f32 v64, v64
    v_exp_f32 v65, v65
    v_exp_f32 v66, v66
    v_mfma_f32_32x32x16_bf16 v[72:87], v[20:23], v[32:35], v[72:87]
    v_exp_f32 v67, v67
    v_exp_f32 v68, v68
    v_exp_f32 v69, v69
    v_exp_f32 v70, v70
    v_exp_f32 v71, v71
    v_cvt_pk_bf16_f32 v36, v64, v65
    v_cvt_pk_bf16_f32 v37, v66, v67
    v_cvt_pk_bf16_f32 v38, v68, v69
    v_cvt_pk_bf16_f32 v39, v70, v71
    s_waitcnt lgkmcnt(0)
    v_mfma_f32_32x32x16_bf16 v[56:71], v[12:15], v[4:7], v[88:103]
    ds_read_b128 v[8:11], v2 offset:8192
    s_mov_b64 exec, s[34:35]
    ds_read_b128 v[20:23], v3 offset:7168
    ds_read_b128 v[24:27], v3 offset:6656
    s_mov_b64 exec, -1
    v_exp_f32 v40, v40
    v_exp_f32 v41, v41
    v_exp_f32 v42, v42
    v_exp_f32 v43, v43
    v_exp_f32 v44, v44
    v_exp_f32 v45, v45
    v_mfma_f32_32x32x16_bf16 v[72:87], v[28:31], v[36:39], v[72:87]
    v_exp_f32 v46, v46
    v_exp_f32 v47, v47
    v_cvt_pk_bf16_f32 v32, v40, v41
    v_cvt_pk_bf16_f32 v33, v42, v43
    v_cvt_pk_bf16_f32 v34, v44, v45
    v_cvt_pk_bf16_f32 v35, v46, v47
    v_exp_f32 v48, v48
    v_exp_f32 v49, v49
    v_exp_f32 v50, v50
    v_mfma_f32_32x32x16_bf16 v[72:87], v[16:19], v[32:35], v[72:87]
    v_exp_f32 v51, v51
    v_exp_f32 v52, v52
    v_exp_f32 v53, v53
    v_exp_f32 v54, v54
    v_exp_f32 v55, v55
    v_cvt_pk_bf16_f32 v36, v48, v49
    v_cvt_pk_bf16_f32 v37, v50, v51
    v_cvt_pk_bf16_f32 v38, v52, v53
    v_cvt_pk_bf16_f32 v39, v54, v55
    s_waitcnt lgkmcnt(0)
    v_mfma_f32_32x32x16_bf16 v[40:55], v[8:11], v[4:7], v[88:103]
    ds_read_b128 v[12:15], v2 offset:9216
    s_mov_b64 exec, s[34:35]
    ds_read_b128 v[16:19], v3 offset:8192
    ds_read_b128 v[28:31], v3 offset:7680
    s_mov_b64 exec, -1
    v_exp_f32 v56, v56
    v_exp_f32 v57, v57
    v_exp_f32 v58, v58
    v_exp_f32 v59, v59
    v_exp_f32 v60, v60
    v_exp_f32 v61, v61
    v_mfma_f32_32x32x16_bf16 v[72:87], v[24:27], v[36:39], v[72:87]
    v_exp_f32 v62, v62
    v_exp_f32 v63, v63
    v_cvt_pk_bf16_f32 v32, v56, v57
    v_cvt_pk_bf16_f32 v33, v58, v59
    v_cvt_pk_bf16_f32 v34, v60, v61
    v_cvt_pk_bf16_f32 v35, v62, v63
    v_exp_f32 v64, v64
    v_exp_f32 v65, v65
    v_exp_f32 v66, v66
    v_mfma_f32_32x32x16_bf16 v[72:87], v[20:23], v[32:35], v[72:87]
    v_exp_f32 v67, v67
    v_exp_f32 v68, v68
    v_exp_f32 v69, v69
    v_exp_f32 v70, v70
    v_exp_f32 v71, v71
    v_cvt_pk_bf16_f32 v36, v64, v65
    v_cvt_pk_bf16_f32 v37, v66, v67
    v_cvt_pk_bf16_f32 v38, v68, v69
    v_cvt_pk_bf16_f32 v39, v70, v71
    v_add_u32 v2, 8192, v2
    v_add_u32 v3, 8192, v3
    s_waitcnt vmcnt(0)
    s_barrier
    v_lshlrev_b32 v108, 7, v1
    s_cmp_lg_u32 s25, 0
    s_cbranch_scc1 att_kernel_pcs1
    s_cmp_lg_u32 s22, 15
    s_cbranch_scc1 att_kernel_pcs1
    s_getpc_b64 s[80:81]
att_kernel_pc2:
    s_add_u32 s80, s80, wo_kernel-att_kernel_pc2
    s_addc_u32 s81, s81, 0
    v_lshlrev_b32 v115, 7, v1
    v_min_u32 v115, wo_kernel_end-wo_kernel-4, v115
    v_mov_b32 v113, s81
    v_add_co_u32 v112, vcc, s80, v115
    s_nop 1
    v_addc_co_u32 v113, vcc, 0, v113, vcc
    global_load_dword v114, v[112:113], off
att_kernel_pcs1:
    s_cmp_ge_u32 s22, 2
    s_cbranch_scc1 att_kernel_pf3
    s_mov_b32 s46, 524288
    s_mov_b32 s47, 0x00020000
    s_lshl_b32 s26, s25, 1
    s_add_u32 s26, s26, s22
    s_lshl_b32 s26, s26, 13
    buffer_load_dword v110, v108, s[44:47], s26 offen
att_kernel_pf3:
    s_sub_u32 s40, s22, 2
    s_cmp_ge_u32 s40, 4
    s_cbranch_scc1 att_kernel_pf4
    s_mov_b32 s50, 1835008
    s_mov_b32 s51, 0x00020000
    v_and_b32 v109, 15, v1
    v_min_u32 v109, 13, v109
    v_lshlrev_b32 v109, 7, v109
    v_lshrrev_b32 v110, 4, v1
    v_mul_u32_u24 v110, 3584, v110
    v_add_u32 v109, v109, v110
    s_lshl_b32 s26, s25, 2
    s_add_u32 s26, s26, s40
    s_mul_i32 s26, s26, 14336
    s_and_b32 s40, s24, 1
    s_mul_i32 s40, s40, 1792
    s_add_u32 s26, s26, s40
    buffer_load_dword v110, v109, s[48:51], s26 offen
att_kernel_pf4:
    s_sub_u32 s40, s22, 8
    s_cmp_ge_u32 s40, 7
    s_cbranch_scc1 att_kernel_pf5
    s_mov_b32 s54, 1835008
    s_mov_b32 s55, 0x00020000
    s_mul_i32 s26, s25, 7
    s_add_u32 s26, s26, s40
    s_lshl_b32 s26, s26, 13
    buffer_load_dword v110, v108, s[52:55], s26 offen
att_kernel_pf5:
    s_setprio 2
    s_waitcnt lgkmcnt(0)
    v_mfma_f32_32x32x16_bf16 v[56:71], v[12:15], v[4:7], v[88:103]
    ds_read_b128 v[8:11], v2 offset:2048
    s_mov_b64 exec, s[34:35]
    ds_read_b128 v[20:23], v3 offset:1024
    ds_read_b128 v[24:27], v3 offset:512
    s_mov_b64 exec, -1
    v_exp_f32 v40, v40
    v_exp_f32 v41, v41
    v_exp_f32 v42, v42
    v_exp_f32 v43, v43
    v_exp_f32 v44, v44
    v_exp_f32 v45, v45
    v_mfma_f32_32x32x16_bf16 v[72:87], v[28:31], v[36:39], v[72:87]
    v_exp_f32 v46, v46
    v_exp_f32 v47, v47
    v_cvt_pk_bf16_f32 v32, v40, v41
    v_cvt_pk_bf16_f32 v33, v42, v43
    v_cvt_pk_bf16_f32 v34, v44, v45
    v_cvt_pk_bf16_f32 v35, v46, v47
    v_exp_f32 v48, v48
    v_exp_f32 v49, v49
    v_exp_f32 v50, v50
    v_mfma_f32_32x32x16_bf16 v[72:87], v[16:19], v[32:35], v[72:87]
    v_exp_f32 v51, v51
    v_exp_f32 v52, v52
    v_exp_f32 v53, v53
    v_exp_f32 v54, v54
    v_exp_f32 v55, v55
    v_cvt_pk_bf16_f32 v36, v48, v49
    v_cvt_pk_bf16_f32 v37, v50, v51
    v_cvt_pk_bf16_f32 v38, v52, v53
    v_cvt_pk_bf16_f32 v39, v54, v55
    s_waitcnt lgkmcnt(0)
    v_mfma_f32_32x32x16_bf16 v[40:55], v[8:11], v[4:7], v[88:103]
    ds_read_b128 v[12:15], v2 offset:3072
    s_mov_b64 exec, s[34:35]
    ds_read_b128 v[16:19], v3 offset:2048
    ds_read_b128 v[28:31], v3 offset:1536
    s_mov_b64 exec, -1
    v_exp_f32 v56, v56
    v_exp_f32 v57, v57
    v_exp_f32 v58, v58
    v_exp_f32 v59, v59
    v_exp_f32 v60, v60
    v_exp_f32 v61, v61
    v_mfma_f32_32x32x16_bf16 v[72:87], v[24:27], v[36:39], v[72:87]
    v_exp_f32 v62, v62
    v_exp_f32 v63, v63
    v_cvt_pk_bf16_f32 v32, v56, v57
    v_cvt_pk_bf16_f32 v33, v58, v59
    v_cvt_pk_bf16_f32 v34, v60, v61
    v_cvt_pk_bf16_f32 v35, v62, v63
    v_exp_f32 v64, v64
    v_exp_f32 v65, v65
    v_exp_f32 v66, v66
    v_mfma_f32_32x32x16_bf16 v[72:87], v[20:23], v[32:35], v[72:87]
    v_exp_f32 v67, v67
    v_exp_f32 v68, v68
    v_exp_f32 v69, v69
    v_exp_f32 v70, v70
    v_exp_f32 v71, v71
    v_cvt_pk_bf16_f32 v36, v64, v65
    v_cvt_pk_bf16_f32 v37, v66, v67
    v_cvt_pk_bf16_f32 v38, v68, v69
    v_cvt_pk_bf16_f32 v39, v70, v71
    s_waitcnt lgkmcnt(0)
    v_mfma_f32_32x32x16_bf16 v[56:71], v[12:15], v[4:7], v[88:103]
    ds_read_b128 v[8:11], v2 offset:4096
    s_mov_b64 exec, s[34:35]
    ds_read_b128 v[20:23], v3 offset:3072
    ds_read_b128 v[24:27], v3 offset:2560
    s_mov_b64 exec, -1
    v_exp_f32 v40, v40
    v_exp_f32 v41, v41
    v_exp_f32 v42, v42
    v_exp_f32 v43, v43
    v_exp_f32 v44, v44
    v_exp_f32 v45, v45
    v_mfma_f32_32x32x16_bf16 v[72:87], v[28:31], v[36:39], v[72:87]
    v_exp_f32 v46, v46
    v_exp_f32 v47, v47
    v_cvt_pk_bf16_f32 v32, v40, v41
    v_cvt_pk_bf16_f32 v33, v42, v43
    v_cvt_pk_bf16_f32 v34, v44, v45
    v_cvt_pk_bf16_f32 v35, v46, v47
    v_exp_f32 v48, v48
    v_exp_f32 v49, v49
    v_exp_f32 v50, v50
    v_mfma_f32_32x32x16_bf16 v[72:87], v[16:19], v[32:35], v[72:87]
    v_exp_f32 v51, v51
    v_exp_f32 v52, v52
    v_exp_f32 v53, v53
    v_exp_f32 v54, v54
    v_exp_f32 v55, v55
    v_cvt_pk_bf16_f32 v36, v48, v49
    v_cvt_pk_bf16_f32 v37, v50, v51
    v_cvt_pk_bf16_f32 v38, v52, v53
    v_cvt_pk_bf16_f32 v39, v54, v55
    s_waitcnt lgkmcnt(0)
    v_mfma_f32_32x32x16_bf16 v[40:55], v[8:11], v[4:7], v[88:103]
    ds_read_b128 v[12:15], v2 offset:5120
    s_mov_b64 exec, s[34:35]
    ds_read_b128 v[16:19], v3 offset:4096
    ds_read_b128 v[28:31], v3 offset:3584
    s_mov_b64 exec, -1
    v_exp_f32 v56, v56
    v_exp_f32 v57, v57
    v_exp_f32 v58, v58
    v_exp_f32 v59, v59
    v_exp_f32 v60, v60
    v_exp_f32 v61, v61
    v_mfma_f32_32x32x16_bf16 v[72:87], v[24:27], v[36:39], v[72:87]
    v_exp_f32 v62, v62
    v_exp_f32 v63, v63
    v_cvt_pk_bf16_f32 v32, v56, v57
    v_cvt_pk_bf16_f32 v33, v58, v59
    v_cvt_pk_bf16_f32 v34, v60, v61
    v_cvt_pk_bf16_f32 v35, v62, v63
    v_exp_f32 v64, v64
    v_exp_f32 v65, v65
    v_exp_f32 v66, v66
    v_mfma_f32_32x32x16_bf16 v[72:87], v[20:23], v[32:35], v[72:87]
    v_exp_f32 v67, v67
    v_exp_f32 v68, v68
    v_exp_f32 v69, v69
    v_exp_f32 v70, v70
    v_exp_f32 v71, v71
    v_cvt_pk_bf16_f32 v36, v64, v65
    v_cvt_pk_bf16_f32 v37, v66, v67
    v_cvt_pk_bf16_f32 v38, v68, v69
    v_cvt_pk_bf16_f32 v39, v70, v71
    s_waitcnt lgkmcnt(0)
    v_mfma_f32_32x32x16_bf16 v[56:71], v[12:15], v[4:7], v[88:103]
    ds_read_b128 v[8:11], v2 offset:6144
    s_mov_b64 exec, s[34:35]
    ds_read_b128 v[20:23], v3 offset:5120
    ds_read_b128 v[24:27], v3 offset:4608
    s_mov_b64 exec, -1
    v_exp_f32 v40, v40
    v_exp_f32 v41, v41
    v_exp_f32 v42, v42
    v_exp_f32 v43, v43
    v_exp_f32 v44, v44
    v_exp_f32 v45, v45
    v_mfma_f32_32x32x16_bf16 v[72:87], v[28:31], v[36:39], v[72:87]
    v_exp_f32 v46, v46
    v_exp_f32 v47, v47
    v_cvt_pk_bf16_f32 v32, v40, v41
    v_cvt_pk_bf16_f32 v33, v42, v43
    v_cvt_pk_bf16_f32 v34, v44, v45
    v_cvt_pk_bf16_f32 v35, v46, v47
    v_exp_f32 v48, v48
    v_exp_f32 v49, v49
    v_exp_f32 v50, v50
    v_mfma_f32_32x32x16_bf16 v[72:87], v[16:19], v[32:35], v[72:87]
    v_exp_f32 v51, v51
    v_exp_f32 v52, v52
    v_exp_f32 v53, v53
    v_exp_f32 v54, v54
    v_exp_f32 v55, v55
    v_cvt_pk_bf16_f32 v36, v48, v49
    v_cvt_pk_bf16_f32 v37, v50, v51
    v_cvt_pk_bf16_f32 v38, v52, v53
    v_cvt_pk_bf16_f32 v39, v54, v55
    s_waitcnt lgkmcnt(0)
    v_mfma_f32_32x32x16_bf16 v[40:55], v[8:11], v[4:7], v[88:103]
    ds_read_b128 v[12:15], v2 offset:7168
    s_mov_b64 exec, s[34:35]
    ds_read_b128 v[16:19], v3 offset:6144
    ds_read_b128 v[28:31], v3 offset:5632
    s_mov_b64 exec, -1
    v_exp_f32 v56, v56
    v_exp_f32 v57, v57
    v_exp_f32 v58, v58
    v_exp_f32 v59, v59
    v_exp_f32 v60, v60
    v_exp_f32 v61, v61
    v_mfma_f32_32x32x16_bf16 v[72:87], v[24:27], v[36:39], v[72:87]
    v_exp_f32 v62, v62
    v_exp_f32 v63, v63
    v_cvt_pk_bf16_f32 v32, v56, v57
    v_cvt_pk_bf16_f32 v33, v58, v59
    v_cvt_pk_bf16_f32 v34, v60, v61
    v_cvt_pk_bf16_f32 v35, v62, v63
    v_exp_f32 v64, v64
    v_exp_f32 v65, v65
    v_exp_f32 v66, v66
    v_mfma_f32_32x32x16_bf16 v[72:87], v[20:23], v[32:35], v[72:87]
    v_exp_f32 v67, v67
    v_exp_f32 v68, v68
    v_exp_f32 v69, v69
    v_exp_f32 v70, v70
    v_exp_f32 v71, v71
    v_cvt_pk_bf16_f32 v36, v64, v65
    v_cvt_pk_bf16_f32 v37, v66, v67
    v_cvt_pk_bf16_f32 v38, v68, v69
    v_cvt_pk_bf16_f32 v39, v70, v71
    s_waitcnt lgkmcnt(0)
    v_mfma_f32_32x32x16_bf16 v[56:71], v[12:15], v[4:7], v[88:103]
    ds_read_b128 v[8:11], v2 offset:8192
    s_mov_b64 exec, s[34:35]
    ds_read_b128 v[20:23], v3 offset:7168
    ds_read_b128 v[24:27], v3 offset:6656
    s_mov_b64 exec, -1
    v_exp_f32 v40, v40
    v_exp_f32 v41, v41
    v_exp_f32 v42, v42
    v_exp_f32 v43, v43
    v_exp_f32 v44, v44
    v_exp_f32 v45, v45
    v_mfma_f32_32x32x16_bf16 v[72:87], v[28:31], v[36:39], v[72:87]
    v_exp_f32 v46, v46
    v_exp_f32 v47, v47
    v_cvt_pk_bf16_f32 v32, v40, v41
    v_cvt_pk_bf16_f32 v33, v42, v43
    v_cvt_pk_bf16_f32 v34, v44, v45
    v_cvt_pk_bf16_f32 v35, v46, v47
    v_exp_f32 v48, v48
    v_exp_f32 v49, v49
    v_exp_f32 v50, v50
    v_mfma_f32_32x32x16_bf16 v[72:87], v[16:19], v[32:35], v[72:87]
    v_exp_f32 v51, v51
    v_exp_f32 v52, v52
    v_exp_f32 v53, v53
    v_exp_f32 v54, v54
    v_exp_f32 v55, v55
    v_cvt_pk_bf16_f32 v36, v48, v49
    v_cvt_pk_bf16_f32 v37, v50, v51
    v_cvt_pk_bf16_f32 v38, v52, v53
    v_cvt_pk_bf16_f32 v39, v54, v55
    s_waitcnt lgkmcnt(0)
    v_mfma_f32_32x32x16_bf16 v[40:55], v[8:11], v[4:7], v[88:103]
    ds_read_b128 v[12:15], v2 offset:9216
    s_mov_b64 exec, s[34:35]
    ds_read_b128 v[16:19], v3 offset:8192
    ds_read_b128 v[28:31], v3 offset:7680
    s_mov_b64 exec, -1
    v_exp_f32 v56, v56
    v_exp_f32 v57, v57
    v_exp_f32 v58, v58
    v_exp_f32 v59, v59
    v_exp_f32 v60, v60
    v_exp_f32 v61, v61
    v_mfma_f32_32x32x16_bf16 v[72:87], v[24:27], v[36:39], v[72:87]
    v_exp_f32 v62, v62
    v_exp_f32 v63, v63
    v_cvt_pk_bf16_f32 v32, v56, v57
    v_cvt_pk_bf16_f32 v33, v58, v59
    v_cvt_pk_bf16_f32 v34, v60, v61
    v_cvt_pk_bf16_f32 v35, v62, v63
    v_exp_f32 v64, v64
    v_exp_f32 v65, v65
    v_exp_f32 v66, v66
    v_mfma_f32_32x32x16_bf16 v[72:87], v[20:23], v[32:35], v[72:87]
    v_exp_f32 v67, v67
    v_exp_f32 v68, v68
    v_exp_f32 v69, v69
    v_exp_f32 v70, v70
    v_exp_f32 v71, v71
    v_cvt_pk_bf16_f32 v36, v64, v65
    v_cvt_pk_bf16_f32 v37, v66, v67
    v_cvt_pk_bf16_f32 v38, v68, v69
    v_cvt_pk_bf16_f32 v39, v70, v71
    v_add_u32 v2, 8192, v2
    v_add_u32 v3, 8192, v3
    s_setprio 1
    s_waitcnt lgkmcnt(0)
    v_mfma_f32_32x32x16_bf16 v[56:71], v[12:15], v[4:7], v[88:103]
    ds_read_b128 v[8:11], v2 offset:2048
    s_mov_b64 exec, s[34:35]
    ds_read_b128 v[20:23], v3 offset:1024
    ds_read_b128 v[24:27], v3 offset:512
    s_mov_b64 exec, -1
    v_exp_f32 v40, v40
    v_exp_f32 v41, v41
    v_exp_f32 v42, v42
    v_exp_f32 v43, v43
    v_exp_f32 v44, v44
    v_exp_f32 v45, v45
    v_mfma_f32_32x32x16_bf16 v[72:87], v[28:31], v[36:39], v[72:87]
    v_exp_f32 v46, v46
    v_exp_f32 v47, v47
    v_cvt_pk_bf16_f32 v32, v40, v41
    v_cvt_pk_bf16_f32 v33, v42, v43
    v_cvt_pk_bf16_f32 v34, v44, v45
    v_cvt_pk_bf16_f32 v35, v46, v47
    v_exp_f32 v48, v48
    v_exp_f32 v49, v49
    v_exp_f32 v50, v50
    v_mfma_f32_32x32x16_bf16 v[72:87], v[16:19], v[32:35], v[72:87]
    v_exp_f32 v51, v51
    v_exp_f32 v52, v52
    v_exp_f32 v53, v53
    v_exp_f32 v54, v54
    v_exp_f32 v55, v55
    v_cvt_pk_bf16_f32 v36, v48, v49
    v_cvt_pk_bf16_f32 v37, v50, v51
    v_cvt_pk_bf16_f32 v38, v52, v53
    v_cvt_pk_bf16_f32 v39, v54, v55
    s_waitcnt lgkmcnt(0)
    v_mfma_f32_32x32x16_bf16 v[40:55], v[8:11], v[4:7], v[88:103]
    ds_read_b128 v[12:15], v2 offset:3072
    s_mov_b64 exec, s[34:35]
    ds_read_b128 v[16:19], v3 offset:2048
    ds_read_b128 v[28:31], v3 offset:1536
    s_mov_b64 exec, -1
    v_exp_f32 v56, v56
    v_exp_f32 v57, v57
    v_exp_f32 v58, v58
    v_exp_f32 v59, v59
    v_exp_f32 v60, v60
    v_exp_f32 v61, v61
    v_mfma_f32_32x32x16_bf16 v[72:87], v[24:27], v[36:39], v[72:87]
    v_exp_f32 v62, v62
    v_exp_f32 v63, v63
    v_cvt_pk_bf16_f32 v32, v56, v57
    v_cvt_pk_bf16_f32 v33, v58, v59
    v_cvt_pk_bf16_f32 v34, v60, v61
    v_cvt_pk_bf16_f32 v35, v62, v63
    v_exp_f32 v64, v64
    v_exp_f32 v65, v65
    v_exp_f32 v66, v66
    v_mfma_f32_32x32x16_bf16 v[72:87], v[20:23], v[32:35], v[72:87]
    v_exp_f32 v67, v67
    v_exp_f32 v68, v68
    v_exp_f32 v69, v69
    v_exp_f32 v70, v70
    v_exp_f32 v71, v71
    v_cvt_pk_bf16_f32 v36, v64, v65
    v_cvt_pk_bf16_f32 v37, v66, v67
    v_cvt_pk_bf16_f32 v38, v68, v69
    v_cvt_pk_bf16_f32 v39, v70, v71
    s_waitcnt lgkmcnt(0)
    v_mfma_f32_32x32x16_bf16 v[56:71], v[12:15], v[4:7], v[88:103]
    ds_read_b128 v[8:11], v2 offset:4096
    s_mov_b64 exec, s[34:35]
    ds_read_b128 v[20:23], v3 offset:3072
    ds_read_b128 v[24:27], v3 offset:2560
    s_mov_b64 exec, -1
    v_exp_f32 v40, v40
    v_exp_f32 v41, v41
    v_exp_f32 v42, v42
    v_exp_f32 v43, v43
    v_exp_f32 v44, v44
    v_exp_f32 v45, v45
    v_mfma_f32_32x32x16_bf16 v[72:87], v[28:31], v[36:39], v[72:87]
    v_exp_f32 v46, v46
    v_exp_f32 v47, v47
    v_cvt_pk_bf16_f32 v32, v40, v41
    v_cvt_pk_bf16_f32 v33, v42, v43
    v_cvt_pk_bf16_f32 v34, v44, v45
    v_cvt_pk_bf16_f32 v35, v46, v47
    v_exp_f32 v48, v48
    v_exp_f32 v49, v49
    v_exp_f32 v50, v50
    v_mfma_f32_32x32x16_bf16 v[72:87], v[16:19], v[32:35], v[72:87]
    v_exp_f32 v51, v51
    v_exp_f32 v52, v52
    v_exp_f32 v53, v53
    v_exp_f32 v54, v54
    v_exp_f32 v55, v55
    v_cvt_pk_bf16_f32 v36, v48, v49
    v_cvt_pk_bf16_f32 v37, v50, v51
    v_cvt_pk_bf16_f32 v38, v52, v53
    v_cvt_pk_bf16_f32 v39, v54, v55
    s_waitcnt lgkmcnt(0)
    v_mfma_f32_32x32x16_bf16 v[40:55], v[8:11], v[4:7], v[88:103]
    ds_read_b128 v[12:15], v2 offset:5120
    s_mov_b64 exec, s[34:35]
    ds_read_b128 v[16:19], v3 offset:4096
    ds_read_b128 v[28:31], v3 offset:3584
    s_mov_b64 exec, -1
    v_exp_f32 v56, v56
    v_exp_f32 v57, v57
    v_exp_f32 v58, v58
    v_exp_f32 v59, v59
    v_exp_f32 v60, v60
    v_exp_f32 v61, v61
    v_mfma_f32_32x32x16_bf16 v[72:87], v[24:27], v[36:39], v[72:87]
    v_exp_f32 v62, v62
    v_exp_f32 v63, v63
    v_cvt_pk_bf16_f32 v32, v56, v57
    v_cvt_pk_bf16_f32 v33, v58, v59
    v_cvt_pk_bf16_f32 v34, v60, v61
    v_cvt_pk_bf16_f32 v35, v62, v63
    v_exp_f32 v64, v64
    v_exp_f32 v65, v65
    v_exp_f32 v66, v66
    v_mfma_f32_32x32x16_bf16 v[72:87], v[20:23], v[32:35], v[72:87]
    v_exp_f32 v67, v67
    v_exp_f32 v68, v68
    v_exp_f32 v69, v69
    v_exp_f32 v70, v70
    v_exp_f32 v71, v71
    v_cvt_pk_bf16_f32 v36, v64, v65
    v_cvt_pk_bf16_f32 v37, v66, v67
    v_cvt_pk_bf16_f32 v38, v68, v69
    v_cvt_pk_bf16_f32 v39, v70, v71
    s_waitcnt lgkmcnt(0)
    v_mfma_f32_32x32x16_bf16 v[56:71], v[12:15], v[4:7], v[88:103]
    ds_read_b128 v[8:11], v2 offset:6144
    s_mov_b64 exec, s[34:35]
    ds_read_b128 v[20:23], v3 offset:5120
    ds_read_b128 v[24:27], v3 offset:4608
    s_mov_b64 exec, -1
    v_exp_f32 v40, v40
    v_exp_f32 v41, v41
    v_exp_f32 v42, v42
    v_exp_f32 v43, v43
    v_exp_f32 v44, v44
    v_exp_f32 v45, v45
    v_mfma_f32_32x32x16_bf16 v[72:87], v[28:31], v[36:39], v[72:87]
    v_exp_f32 v46, v46
    v_exp_f32 v47, v47
    v_cvt_pk_bf16_f32 v32, v40, v41
    v_cvt_pk_bf16_f32 v33, v42, v43
    v_cvt_pk_bf16_f32 v34, v44, v45
    v_cvt_pk_bf16_f32 v35, v46, v47
    v_exp_f32 v48, v48
    v_exp_f32 v49, v49
    v_exp_f32 v50, v50
    v_mfma_f32_32x32x16_bf16 v[72:87], v[16:19], v[32:35], v[72:87]
    v_exp_f32 v51, v51
    v_exp_f32 v52, v52
    v_exp_f32 v53, v53
    v_exp_f32 v54, v54
    v_exp_f32 v55, v55
    v_cvt_pk_bf16_f32 v36, v48, v49
    v_cvt_pk_bf16_f32 v37, v50, v51
    v_cvt_pk_bf16_f32 v38, v52, v53
    v_cvt_pk_bf16_f32 v39, v54, v55
    s_waitcnt lgkmcnt(0)
    v_mfma_f32_32x32x16_bf16 v[40:55], v[8:11], v[4:7], v[88:103]
    ds_read_b128 v[12:15], v2 offset:7168
    s_mov_b64 exec, s[34:35]
    ds_read_b128 v[16:19], v3 offset:6144
    ds_read_b128 v[28:31], v3 offset:5632
    s_mov_b64 exec, -1
    v_exp_f32 v56, v56
    v_exp_f32 v57, v57
    v_exp_f32 v58, v58
    v_exp_f32 v59, v59
    v_exp_f32 v60, v60
    v_exp_f32 v61, v61
    v_mfma_f32_32x32x16_bf16 v[72:87], v[24:27], v[36:39], v[72:87]
    v_exp_f32 v62, v62
    v_exp_f32 v63, v63
    v_cvt_pk_bf16_f32 v32, v56, v57
    v_cvt_pk_bf16_f32 v33, v58, v59
    v_cvt_pk_bf16_f32 v34, v60, v61
    v_cvt_pk_bf16_f32 v35, v62, v63
    v_exp_f32 v64, v64
    v_exp_f32 v65, v65
    v_exp_f32 v66, v66
    v_mfma_f32_32x32x16_bf16 v[72:87], v[20:23], v[32:35], v[72:87]
    v_exp_f32 v67, v67
    v_exp_f32 v68, v68
    v_exp_f32 v69, v69
    v_exp_f32 v70, v70
    v_exp_f32 v71, v71
    v_cvt_pk_bf16_f32 v36, v64, v65
    v_cvt_pk_bf16_f32 v37, v66, v67
    v_cvt_pk_bf16_f32 v38, v68, v69
    v_cvt_pk_bf16_f32 v39, v70, v71
    s_waitcnt lgkmcnt(0)
    v_mfma_f32_32x32x16_bf16 v[56:71], v[12:15], v[4:7], v[88:103]
    ds_read_b128 v[8:11], v2 offset:8192
    s_mov_b64 exec, s[34:35]
    ds_read_b128 v[20:23], v3 offset:7168
    ds_read_b128 v[24:27], v3 offset:6656
    s_mov_b64 exec, -1
    v_exp_f32 v40, v40
    v_exp_f32 v41, v41
    v_exp_f32 v42, v42
    v_exp_f32 v43, v43
    v_exp_f32 v44, v44
    v_exp_f32 v45, v45
    v_mfma_f32_32x32x16_bf16 v[72:87], v[28:31], v[36:39], v[72:87]
    v_exp_f32 v46, v46
    v_exp_f32 v47, v47
    v_cvt_pk_bf16_f32 v32, v40, v41
    v_cvt_pk_bf16_f32 v33, v42, v43
    v_cvt_pk_bf16_f32 v34, v44, v45
    v_cvt_pk_bf16_f32 v35, v46, v47
    v_exp_f32 v48, v48
    v_exp_f32 v49, v49
    v_exp_f32 v50, v50
    v_mfma_f32_32x32x16_bf16 v[72:87], v[16:19], v[32:35], v[72:87]
    v_exp_f32 v51, v51
    v_exp_f32 v52, v52
    v_exp_f32 v53, v53
    v_exp_f32 v54, v54
    v_exp_f32 v55, v55
    v_cvt_pk_bf16_f32 v36, v48, v49
    v_cvt_pk_bf16_f32 v37, v50, v51
    v_cvt_pk_bf16_f32 v38, v52, v53
    v_cvt_pk_bf16_f32 v39, v54, v55
    s_waitcnt lgkmcnt(0)
    v_mfma_f32_32x32x16_bf16 v[40:55], v[8:11], v[4:7], v[88:103]
    ds_read_b128 v[12:15], v2 offset:9216
    s_mov_b64 exec, s[34:35]
    ds_read_b128 v[16:19], v3 offset:8192
    ds_read_b128 v[28:31], v3 offset:7680
    s_mov_b64 exec, -1
    v_exp_f32 v56, v56
    v_exp_f32 v57, v57
    v_exp_f32 v58, v58
    v_exp_f32 v59, v59
    v_exp_f32 v60, v60
    v_exp_f32 v61, v61
    v_mfma_f32_32x32x16_bf16 v[72:87], v[24:27], v[36:39], v[72:87]
    v_exp_f32 v62, v62
    v_exp_f32 v63, v63
    v_cvt_pk_bf16_f32 v32, v56, v57
    v_cvt_pk_bf16_f32 v33, v58, v59
    v_cvt_pk_bf16_f32 v34, v60, v61
    v_cvt_pk_bf16_f32 v35, v62, v63
    v_exp_f32 v64, v64
    v_exp_f32 v65, v65
    v_exp_f32 v66, v66
    v_mfma_f32_32x32x16_bf16 v[72:87], v[20:23], v[32:35], v[72:87]
    v_exp_f32 v67, v67
    v_exp_f32 v68, v68
    v_exp_f32 v69, v69
    v_exp_f32 v70, v70
    v_exp_f32 v71, v71
    v_cvt_pk_bf16_f32 v36, v64, v65
    v_cvt_pk_bf16_f32 v37, v66, v67
    v_cvt_pk_bf16_f32 v38, v68, v69
    v_cvt_pk_bf16_f32 v39, v70, v71
    v_add_u32 v2, 8192, v2
    v_add_u32 v3, 8192, v3
    s_setprio 0
    s_waitcnt lgkmcnt(0)
    v_mfma_f32_32x32x16_bf16 v[56:71], v[12:15], v[4:7], v[88:103]
    ds_read_b128 v[8:11], v2 offset:2048
    s_mov_b64 exec, s[34:35]
    ds_read_b128 v[20:23], v3 offset:1024
    ds_read_b128 v[24:27], v3 offset:512
    s_mov_b64 exec, -1
    v_exp_f32 v40, v40
    v_exp_f32 v41, v41
    v_exp_f32 v42, v42
    v_exp_f32 v43, v43
    v_exp_f32 v44, v44
    v_exp_f32 v45, v45
    v_mfma_f32_32x32x16_bf16 v[72:87], v[28:31], v[36:39], v[72:87]
    v_exp_f32 v46, v46
    v_exp_f32 v47, v47
    v_cvt_pk_bf16_f32 v32, v40, v41
    v_cvt_pk_bf16_f32 v33, v42, v43
    v_cvt_pk_bf16_f32 v34, v44, v45
    v_cvt_pk_bf16_f32 v35, v46, v47
    v_exp_f32 v48, v48
    v_exp_f32 v49, v49
    v_exp_f32 v50, v50
    v_mfma_f32_32x32x16_bf16 v[72:87], v[16:19], v[32:35], v[72:87]
    v_exp_f32 v51, v51
    v_exp_f32 v52, v52
    v_exp_f32 v53, v53
    v_exp_f32 v54, v54
    v_exp_f32 v55, v55
    v_cvt_pk_bf16_f32 v36, v48, v49
    v_cvt_pk_bf16_f32 v37, v50, v51
    v_cvt_pk_bf16_f32 v38, v52, v53
    v_cvt_pk_bf16_f32 v39, v54, v55
    s_waitcnt lgkmcnt(0)
    v_mfma_f32_32x32x16_bf16 v[40:55], v[8:11], v[4:7], v[88:103]
    ds_read_b128 v[12:15], v2 offset:3072
    s_mov_b64 exec, s[34:35]
    ds_read_b128 v[16:19], v3 offset:2048
    ds_read_b128 v[28:31], v3 offset:1536
    s_mov_b64 exec, -1
    v_exp_f32 v56, v56
    v_exp_f32 v57, v57
    v_exp_f32 v58, v58
    v_exp_f32 v59, v59
    v_exp_f32 v60, v60
    v_exp_f32 v61, v61
    v_mfma_f32_32x32x16_bf16 v[72:87], v[24:27], v[36:39], v[72:87]
    v_exp_f32 v62, v62
    v_exp_f32 v63, v63
    v_cvt_pk_bf16_f32 v32, v56, v57
    v_cvt_pk_bf16_f32 v33, v58, v59
    v_cvt_pk_bf16_f32 v34, v60, v61
    v_cvt_pk_bf16_f32 v35, v62, v63
    v_exp_f32 v64, v64
    v_exp_f32 v65, v65
    v_exp_f32 v66, v66
    v_mfma_f32_32x32x16_bf16 v[72:87], v[20:23], v[32:35], v[72:87]
    v_exp_f32 v67, v67
    v_exp_f32 v68, v68
    v_exp_f32 v69, v69
    v_exp_f32 v70, v70
    v_exp_f32 v71, v71
    v_cvt_pk_bf16_f32 v36, v64, v65
    v_cvt_pk_bf16_f32 v37, v66, v67
    v_cvt_pk_bf16_f32 v38, v68, v69
    v_cvt_pk_bf16_f32 v39, v70, v71
    s_waitcnt lgkmcnt(0)
    v_mfma_f32_32x32x16_bf16 v[56:71], v[12:15], v[4:7], v[88:103]
    ds_read_b128 v[8:11], v2 offset:4096
    s_mov_b64 exec, s[34:35]
    ds_read_b128 v[20:23], v3 offset:3072
    ds_read_b128 v[24:27], v3 offset:2560
    s_mov_b64 exec, -1
    v_exp_f32 v40, v40
    v_exp_f32 v41, v41
    v_exp_f32 v42, v42
    v_exp_f32 v43, v43
    v_exp_f32 v44, v44
    v_exp_f32 v45, v45
    v_mfma_f32_32x32x16_bf16 v[72:87], v[28:31], v[36:39], v[72:87]
    v_exp_f32 v46, v46
    v_exp_f32 v47, v47
    v_cvt_pk_bf16_f32 v32, v40, v41
    v_cvt_pk_bf16_f32 v33, v42, v43
    v_cvt_pk_bf16_f32 v34, v44, v45
    v_cvt_pk_bf16_f32 v35, v46, v47
    v_exp_f32 v48, v48
    v_exp_f32 v49, v49
    v_exp_f32 v50, v50
    v_mfma_f32_32x32x16_bf16 v[72:87], v[16:19], v[32:35], v[72:87]
    v_exp_f32 v51, v51
    v_exp_f32 v52, v52
    v_exp_f32 v53, v53
    v_exp_f32 v54, v54
    v_exp_f32 v55, v55
    v_cvt_pk_bf16_f32 v36, v48, v49
    v_cvt_pk_bf16_f32 v37, v50, v51
    v_cvt_pk_bf16_f32 v38, v52, v53
    v_cvt_pk_bf16_f32 v39, v54, v55
    s_waitcnt lgkmcnt(0)
    v_mfma_f32_32x32x16_bf16 v[40:55], v[8:11], v[4:7], v[88:103]
    ds_read_b128 v[12:15], v2 offset:5120
    s_mov_b64 exec, s[34:35]
    ds_read_b128 v[16:19], v3 offset:4096
    ds_read_b128 v[28:31], v3 offset:3584
    s_mov_b64 exec, -1
    v_exp_f32 v56, v56
    v_exp_f32 v57, v57
    v_exp_f32 v58, v58
    v_exp_f32 v59, v59
    v_exp_f32 v60, v60
    v_exp_f32 v61, v61
    v_mfma_f32_32x32x16_bf16 v[72:87], v[24:27], v[36:39], v[72:87]
    v_exp_f32 v62, v62
    v_exp_f32 v63, v63
    v_cvt_pk_bf16_f32 v32, v56, v57
    v_cvt_pk_bf16_f32 v33, v58, v59
    v_cvt_pk_bf16_f32 v34, v60, v61
    v_cvt_pk_bf16_f32 v35, v62, v63
    v_exp_f32 v64, v64
    v_exp_f32 v65, v65
    v_exp_f32 v66, v66
    v_mfma_f32_32x32x16_bf16 v[72:87], v[20:23], v[32:35], v[72:87]
    v_exp_f32 v67, v67
    v_exp_f32 v68, v68
    v_exp_f32 v69, v69
    v_exp_f32 v70, v70
    v_exp_f32 v71, v71
    v_cvt_pk_bf16_f32 v36, v64, v65
    v_cvt_pk_bf16_f32 v37, v66, v67
    v_cvt_pk_bf16_f32 v38, v68, v69
    v_cvt_pk_bf16_f32 v39, v70, v71
    s_waitcnt lgkmcnt(0)
    v_mfma_f32_32x32x16_bf16 v[56:71], v[12:15], v[4:7], v[88:103]
    ds_read_b128 v[8:11], v2 offset:6144
    s_mov_b64 exec, s[34:35]
    ds_read_b128 v[20:23], v3 offset:5120
    ds_read_b128 v[24:27], v3 offset:4608
    s_mov_b64 exec, -1
    v_exp_f32 v40, v40
    v_exp_f32 v41, v41
    v_exp_f32 v42, v42
    v_exp_f32 v43, v43
    v_exp_f32 v44, v44
    v_exp_f32 v45, v45
    v_mfma_f32_32x32x16_bf16 v[72:87], v[28:31], v[36:39], v[72:87]
    v_exp_f32 v46, v46
    v_exp_f32 v47, v47
    v_cvt_pk_bf16_f32 v32, v40, v41
    v_cvt_pk_bf16_f32 v33, v42, v43
    v_cvt_pk_bf16_f32 v34, v44, v45
    v_cvt_pk_bf16_f32 v35, v46, v47
    v_exp_f32 v48, v48
    v_exp_f32 v49, v49
    v_exp_f32 v50, v50
    v_mfma_f32_32x32x16_bf16 v[72:87], v[16:19], v[32:35], v[72:87]
    v_exp_f32 v51, v51
    v_exp_f32 v52, v52
    v_exp_f32 v53, v53
    v_exp_f32 v54, v54
    v_exp_f32 v55, v55
    v_cvt_pk_bf16_f32 v36, v48, v49
    v_cvt_pk_bf16_f32 v37, v50, v51
    v_cvt_pk_bf16_f32 v38, v52, v53
    v_cvt_pk_bf16_f32 v39, v54, v55
    s_waitcnt lgkmcnt(0)
    v_mfma_f32_32x32x16_bf16 v[40:55], v[8:11], v[4:7], v[88:103]
    ds_read_b128 v[12:15], v2 offset:7168
    s_mov_b64 exec, s[34:35]
    ds_read_b128 v[16:19], v3 offset:6144
    ds_read_b128 v[28:31], v3 offset:5632
    s_mov_b64 exec, -1
    v_exp_f32 v56, v56
    v_exp_f32 v57, v57
    v_exp_f32 v58, v58
    v_exp_f32 v59, v59
    v_exp_f32 v60, v60
    v_exp_f32 v61, v61
    v_mfma_f32_32x32x16_bf16 v[72:87], v[24:27], v[36:39], v[72:87]
    v_exp_f32 v62, v62
    v_exp_f32 v63, v63
    v_cvt_pk_bf16_f32 v32, v56, v57
    v_cvt_pk_bf16_f32 v33, v58, v59
    v_cvt_pk_bf16_f32 v34, v60, v61
    v_cvt_pk_bf16_f32 v35, v62, v63
    v_exp_f32 v64, v64
    v_exp_f32 v65, v65
    v_exp_f32 v66, v66
    v_mfma_f32_32x32x16_bf16 v[72:87], v[20:23], v[32:35], v[72:87]
    v_exp_f32 v67, v67
    v_exp_f32 v68, v68
    v_exp_f32 v69, v69
    v_exp_f32 v70, v70
    v_exp_f32 v71, v71
    v_cvt_pk_bf16_f32 v36, v64, v65
    v_cvt_pk_bf16_f32 v37, v66, v67
    v_cvt_pk_bf16_f32 v38, v68, v69
    v_cvt_pk_bf16_f32 v39, v70, v71
    s_waitcnt lgkmcnt(0)
    v_mfma_f32_32x32x16_bf16 v[56:71], v[12:15], v[4:7], v[88:103]
    ds_read_b128 v[8:11], v2 offset:8192
    s_mov_b64 exec, s[34:35]
    ds_read_b128 v[20:23], v3 offset:7168
    ds_read_b128 v[24:27], v3 offset:6656
    s_mov_b64 exec, -1
    v_exp_f32 v40, v40
    v_exp_f32 v41, v41
    v_exp_f32 v42, v42
    v_exp_f32 v43, v43
    v_exp_f32 v44, v44
    v_exp_f32 v45, v45
    v_mfma_f32_32x32x16_bf16 v[72:87], v[28:31], v[36:39], v[72:87]
    v_exp_f32 v46, v46
    v_exp_f32 v47, v47
    v_cvt_pk_bf16_f32 v32, v40, v41
    v_cvt_pk_bf16_f32 v33, v42, v43
    v_cvt_pk_bf16_f32 v34, v44, v45
    v_cvt_pk_bf16_f32 v35, v46, v47
    v_exp_f32 v48, v48
    v_exp_f32 v49, v49
    v_exp_f32 v50, v50
    v_mfma_f32_32x32x16_bf16 v[72:87], v[16:19], v[32:35], v[72:87]
    v_exp_f32 v51, v51
    v_exp_f32 v52, v52
    v_exp_f32 v53, v53
    v_exp_f32 v54, v54
    v_exp_f32 v55, v55
    v_cvt_pk_bf16_f32 v36, v48, v49
    v_cvt_pk_bf16_f32 v37, v50, v51
    v_cvt_pk_bf16_f32 v38, v52, v53
    v_cvt_pk_bf16_f32 v39, v54, v55
    s_waitcnt lgkmcnt(0)
    v_mfma_f32_32x32x16_bf16 v[40:55], v[8:11], v[4:7], v[88:103]
    ds_read_b128 v[12:15], v2 offset:9216
    s_mov_b64 exec, s[34:35]
    ds_read_b128 v[16:19], v3 offset:8192
    ds_read_b128 v[28:31], v3 offset:7680
    s_mov_b64 exec, -1
    v_exp_f32 v56, v56
    v_exp_f32 v57, v57
    v_exp_f32 v58, v58
    v_exp_f32 v59, v59
    v_exp_f32 v60, v60
    v_exp_f32 v61, v61
    v_mfma_f32_32x32x16_bf16 v[72:87], v[24:27], v[36:39], v[72:87]
    v_exp_f32 v62, v62
    v_exp_f32 v63, v63
    v_cvt_pk_bf16_f32 v32, v56, v57
    v_cvt_pk_bf16_f32 v33, v58, v59
    v_cvt_pk_bf16_f32 v34, v60, v61
    v_cvt_pk_bf16_f32 v35, v62, v63
    v_exp_f32 v64, v64
    v_exp_f32 v65, v65
    v_exp_f32 v66, v66
    v_mfma_f32_32x32x16_bf16 v[72:87], v[20:23], v[32:35], v[72:87]
    v_exp_f32 v67, v67
    v_exp_f32 v68, v68
    v_exp_f32 v69, v69
    v_exp_f32 v70, v70
    v_exp_f32 v71, v71
    v_cvt_pk_bf16_f32 v36, v64, v65
    v_cvt_pk_bf16_f32 v37, v66, v67
    v_cvt_pk_bf16_f32 v38, v68, v69
    v_cvt_pk_bf16_f32 v39, v70, v71
    v_add_u32 v2, 8192, v2
    v_add_u32 v3, 8192, v3
    s_branch att_loop_end
    s_mov_b32 s38, 1
att_loop:
    s_waitcnt lgkmcnt(0)
    v_mfma_f32_32x32x16_bf16 v[56:71], v[12:15], v[4:7], v[88:103]
    ds_read_b128 v[8:11], v2 offset:2048
    s_mov_b64 exec, s[34:35]
    ds_read_b128 v[20:23], v3 offset:1024
    ds_read_b128 v[24:27], v3 offset:512
    s_mov_b64 exec, -1
    v_exp_f32 v40, v40
    v_exp_f32 v41, v41
    v_exp_f32 v42, v42
    v_exp_f32 v43, v43
    v_exp_f32 v44, v44
    v_exp_f32 v45, v45
    v_mfma_f32_32x32x16_bf16 v[72:87], v[28:31], v[36:39], v[72:87]
    v_exp_f32 v46, v46
    v_exp_f32 v47, v47
    v_cvt_pk_bf16_f32 v32, v40, v41
    v_cvt_pk_bf16_f32 v33, v42, v43
    v_cvt_pk_bf16_f32 v34, v44, v45
    v_cvt_pk_bf16_f32 v35, v46, v47
    v_exp_f32 v48, v48
    v_exp_f32 v49, v49
    v_exp_f32 v50, v50
    v_mfma_f32_32x32x16_bf16 v[72:87], v[16:19], v[32:35], v[72:87]
    v_exp_f32 v51, v51
    v_exp_f32 v52, v52
    v_exp_f32 v53, v53
    v_exp_f32 v54, v54
    v_exp_f32 v55, v55
    v_cvt_pk_bf16_f32 v36, v48, v49
    v_cvt_pk_bf16_f32 v37, v50, v51
    v_cvt_pk_bf16_f32 v38, v52, v53
    v_cvt_pk_bf16_f32 v39, v54, v55
    s_waitcnt lgkmcnt(0)
    v_mfma_f32_32x32x16_bf16 v[40:55], v[8:11], v[4:7], v[88:103]
    ds_read_b128 v[12:15], v2 offset:3072
    s_mov_b64 exec, s[34:35]
    ds_read_b128 v[16:19], v3 offset:2048
    ds_read_b128 v[28:31], v3 offset:1536
    s_mov_b64 exec, -1
    v_exp_f32 v56, v56
    v_exp_f32 v57, v57
    v_exp_f32 v58, v58
    v_exp_f32 v59, v59
    v_exp_f32 v60, v60
    v_exp_f32 v61, v61
    v_mfma_f32_32x32x16_bf16 v[72:87], v[24:27], v[36:39], v[72:87]
    v_exp_f32 v62, v62
    v_exp_f32 v63, v63
    v_cvt_pk_bf16_f32 v32, v56, v57
    v_cvt_pk_bf16_f32 v33, v58, v59
    v_cvt_pk_bf16_f32 v34, v60, v61
    v_cvt_pk_bf16_f32 v35, v62, v63
    v_exp_f32 v64, v64
    v_exp_f32 v65, v65
    v_exp_f32 v66, v66
    v_mfma_f32_32x32x16_bf16 v[72:87], v[20:23], v[32:35], v[72:87]
    v_exp_f32 v67, v67
    v_exp_f32 v68, v68
    v_exp_f32 v69, v69
    v_exp_f32 v70, v70
    v_exp_f32 v71, v71
    v_cvt_pk_bf16_f32 v36, v64, v65
    v_cvt_pk_bf16_f32 v37, v66, v67
    v_cvt_pk_bf16_f32 v38, v68, v69
    v_cvt_pk_bf16_f32 v39, v70, v71
    s_waitcnt lgkmcnt(0)
    v_mfma_f32_32x32x16_bf16 v[56:71], v[12:15], v[4:7], v[88:103]
    ds_read_b128 v[8:11], v2 offset:4096
    s_mov_b64 exec, s[34:35]
    ds_read_b128 v[20:23], v3 offset:3072
    ds_read_b128 v[24:27], v3 offset:2560
    s_mov_b64 exec, -1
    v_exp_f32 v40, v40
    v_exp_f32 v41, v41
    v_exp_f32 v42, v42
    v_exp_f32 v43, v43
    v_exp_f32 v44, v44
    v_exp_f32 v45, v45
    v_mfma_f32_32x32x16_bf16 v[72:87], v[28:31], v[36:39], v[72:87]
    v_exp_f32 v46, v46
    v_exp_f32 v47, v47
    v_cvt_pk_bf16_f32 v32, v40, v41
    v_cvt_pk_bf16_f32 v33, v42, v43
    v_cvt_pk_bf16_f32 v34, v44, v45
    v_cvt_pk_bf16_f32 v35, v46, v47
    v_exp_f32 v48, v48
    v_exp_f32 v49, v49
    v_exp_f32 v50, v50
    v_mfma_f32_32x32x16_bf16 v[72:87], v[16:19], v[32:35], v[72:87]
    v_exp_f32 v51, v51
    v_exp_f32 v52, v52
    v_exp_f32 v53, v53
    v_exp_f32 v54, v54
    v_exp_f32 v55, v55
    v_cvt_pk_bf16_f32 v36, v48, v49
    v_cvt_pk_bf16_f32 v37, v50, v51
    v_cvt_pk_bf16_f32 v38, v52, v53
    v_cvt_pk_bf16_f32 v39, v54, v55
    s_waitcnt lgkmcnt(0)
    v_mfma_f32_32x32x16_bf16 v[40:55], v[8:11], v[4:7], v[88:103]
    ds_read_b128 v[12:15], v2 offset:5120
    s_mov_b64 exec, s[34:35]
    ds_read_b128 v[16:19], v3 offset:4096
    ds_read_b128 v[28:31], v3 offset:3584
    s_mov_b64 exec, -1
    v_exp_f32 v56, v56
    v_exp_f32 v57, v57
    v_exp_f32 v58, v58
    v_exp_f32 v59, v59
    v_exp_f32 v60, v60
    v_exp_f32 v61, v61
    v_mfma_f32_32x32x16_bf16 v[72:87], v[24:27], v[36:39], v[72:87]
    v_exp_f32 v62, v62
    v_exp_f32 v63, v63
    v_cvt_pk_bf16_f32 v32, v56, v57
    v_cvt_pk_bf16_f32 v33, v58, v59
    v_cvt_pk_bf16_f32 v34, v60, v61
    v_cvt_pk_bf16_f32 v35, v62, v63
    v_exp_f32 v64, v64
    v_exp_f32 v65, v65
    v_exp_f32 v66, v66
    v_mfma_f32_32x32x16_bf16 v[72:87], v[20:23], v[32:35], v[72:87]
    v_exp_f32 v67, v67
    v_exp_f32 v68, v68
    v_exp_f32 v69, v69
    v_exp_f32 v70, v70
    v_exp_f32 v71, v71
    v_cvt_pk_bf16_f32 v36, v64, v65
    v_cvt_pk_bf16_f32 v37, v66, v67
    v_cvt_pk_bf16_f32 v38, v68, v69
    v_cvt_pk_bf16_f32 v39, v70, v71
    s_waitcnt lgkmcnt(0)
    v_mfma_f32_32x32x16_bf16 v[56:71], v[12:15], v[4:7], v[88:103]
    ds_read_b128 v[8:11], v2 offset:6144
    s_mov_b64 exec, s[34:35]
    ds_read_b128 v[20:23], v3 offset:5120
    ds_read_b128 v[24:27], v3 offset:4608
    s_mov_b64 exec, -1
    v_exp_f32 v40, v40
    v_exp_f32 v41, v41
    v_exp_f32 v42, v42
    v_exp_f32 v43, v43
    v_exp_f32 v44, v44
    v_exp_f32 v45, v45
    v_mfma_f32_32x32x16_bf16 v[72:87], v[28:31], v[36:39], v[72:87]
    v_exp_f32 v46, v46
    v_exp_f32 v47, v47
    v_cvt_pk_bf16_f32 v32, v40, v41
    v_cvt_pk_bf16_f32 v33, v42, v43
    v_cvt_pk_bf16_f32 v34, v44, v45
    v_cvt_pk_bf16_f32 v35, v46, v47
    v_exp_f32 v48, v48
    v_exp_f32 v49, v49
    v_exp_f32 v50, v50
    v_mfma_f32_32x32x16_bf16 v[72:87], v[16:19], v[32:35], v[72:87]
    v_exp_f32 v51, v51
    v_exp_f32 v52, v52
    v_exp_f32 v53, v53
    v_exp_f32 v54, v54
    v_exp_f32 v55, v55
    v_cvt_pk_bf16_f32 v36, v48, v49
    v_cvt_pk_bf16_f32 v37, v50, v51
    v_cvt_pk_bf16_f32 v38, v52, v53
    v_cvt_pk_bf16_f32 v39, v54, v55
    s_waitcnt lgkmcnt(0)
    v_mfma_f32_32x32x16_bf16 v[40:55], v[8:11], v[4:7], v[88:103]
    ds_read_b128 v[12:15], v2 offset:7168
    s_mov_b64 exec, s[34:35]
    ds_read_b128 v[16:19], v3 offset:6144
    ds_read_b128 v[28:31], v3 offset:5632
    s_mov_b64 exec, -1
    v_exp_f32 v56, v56
    v_exp_f32 v57, v57
    v_exp_f32 v58, v58
    v_exp_f32 v59, v59
    v_exp_f32 v60, v60
    v_exp_f32 v61, v61
    v_mfma_f32_32x32x16_bf16 v[72:87], v[24:27], v[36:39], v[72:87]
    v_exp_f32 v62, v62
    v_exp_f32 v63, v63
    v_cvt_pk_bf16_f32 v32, v56, v57
    v_cvt_pk_bf16_f32 v33, v58, v59
    v_cvt_pk_bf16_f32 v34, v60, v61
    v_cvt_pk_bf16_f32 v35, v62, v63
    v_exp_f32 v64, v64
    v_exp_f32 v65, v65
    v_exp_f32 v66, v66
    v_mfma_f32_32x32x16_bf16 v[72:87], v[20:23], v[32:35], v[72:87]
    v_exp_f32 v67, v67
    v_exp_f32 v68, v68
    v_exp_f32 v69, v69
    v_exp_f32 v70, v70
    v_exp_f32 v71, v71
    v_cvt_pk_bf16_f32 v36, v64, v65
    v_cvt_pk_bf16_f32 v37, v66, v67
    v_cvt_pk_bf16_f32 v38, v68, v69
    v_cvt_pk_bf16_f32 v39, v70, v71
    s_waitcnt lgkmcnt(0)
    v_mfma_f32_32x32x16_bf16 v[56:71], v[12:15], v[4:7], v[88:103]
    ds_read_b128 v[8:11], v2 offset:8192
    s_mov_b64 exec, s[34:35]
    ds_read_b128 v[20:23], v3 offset:7168
    ds_read_b128 v[24:27], v3 offset:6656
    s_mov_b64 exec, -1
    v_exp_f32 v40, v40
    v_exp_f32 v41, v41
    v_exp_f32 v42, v42
    v_exp_f32 v43, v43
    v_exp_f32 v44, v44
    v_exp_f32 v45, v45
    v_mfma_f32_32x32x16_bf16 v[72:87], v[28:31], v[36:39], v[72:87]
    v_exp_f32 v46, v46
    v_exp_f32 v47, v47
    v_cvt_pk_bf16_f32 v32, v40, v41
    v_cvt_pk_bf16_f32 v33, v42, v43
    v_cvt_pk_bf16_f32 v34, v44, v45
    v_cvt_pk_bf16_f32 v35, v46, v47
    v_exp_f32 v48, v48
    v_exp_f32 v49, v49
    v_exp_f32 v50, v50
    v_mfma_f32_32x32x16_bf16 v[72:87], v[16:19], v[32:35], v[72:87]
    v_exp_f32 v51, v51
    v_exp_f32 v52, v52
    v_exp_f32 v53, v53
    v_exp_f32 v54, v54
    v_exp_f32 v55, v55
    v_cvt_pk_bf16_f32 v36, v48, v49
    v_cvt_pk_bf16_f32 v37, v50, v51
    v_cvt_pk_bf16_f32 v38, v52, v53
    v_cvt_pk_bf16_f32 v39, v54, v55
    s_waitcnt lgkmcnt(0)
    v_mfma_f32_32x32x16_bf16 v[40:55], v[8:11], v[4:7], v[88:103]
    ds_read_b128 v[12:15], v2 offset:9216
    s_mov_b64 exec, s[34:35]
    ds_read_b128 v[16:19], v3 offset:8192
    ds_read_b128 v[28:31], v3 offset:7680
    s_mov_b64 exec, -1
    v_exp_f32 v56, v56
    v_exp_f32 v57, v57
    v_exp_f32 v58, v58
    v_exp_f32 v59, v59
    v_exp_f32 v60, v60
    v_exp_f32 v61, v61
    v_mfma_f32_32x32x16_bf16 v[72:87], v[24:27], v[36:39], v[72:87]
    v_exp_f32 v62, v62
    v_exp_f32 v63, v63
    v_cvt_pk_bf16_f32 v32, v56, v57
    v_cvt_pk_bf16_f32 v33, v58, v59
    v_cvt_pk_bf16_f32 v34, v60, v61
    v_cvt_pk_bf16_f32 v35, v62, v63
    v_exp_f32 v64, v64
    v_exp_f32 v65, v65
    v_exp_f32 v66, v66
    v_mfma_f32_32x32x16_bf16 v[72:87], v[20:23], v[32:35], v[72:87]
    v_exp_f32 v67, v67
    v_exp_f32 v68, v68
    v_exp_f32 v69, v69
    v_exp_f32 v70, v70
    v_exp_f32 v71, v71
    v_cvt_pk_bf16_f32 v36, v64, v65
    v_cvt_pk_bf16_f32 v37, v66, v67
    v_cvt_pk_bf16_f32 v38, v68, v69
    v_cvt_pk_bf16_f32 v39, v70, v71
    v_add_u32 v2, 8192, v2
    v_add_u32 v3, 8192, v3
    s_add_u32 s38, s38, 1
    s_cmp_lt_u32 s38, 4
    s_cbranch_scc1 att_loop
att_loop_end:
    s_waitcnt lgkmcnt(0)
    v_mfma_f32_32x32x16_bf16 v[72:87], v[28:31], v[36:39], v[72:87]
    s_nop 15
    v_add_f32 v104, |v72|, |v73|
    v_add_f32 v105, |v74|, |v75|
    v_add_f32 v108, |v76|, |v77|
    v_add_f32 v109, |v78|, |v79|
    v_add_f32 v104, v104, v105
    v_add_f32 v108, v108, v109
    v_add_f32 v104, v104, v108
    v_mul_f32 v104, 0x35800000, v104
    v_add_f32 v104, v104, v80
    v_mov_b32 v108, 0x71800000
    v_cmp_nlt_f32 vcc, v104, v108
    s_nop 3
    s_cmp_eq_u64 vcc, 0
    s_cbranch_scc1 att_ok
    s_cmp_lg_u32 s36, 0
    s_cbranch_scc1 att_ok
    s_mov_b32 s36, 1
    s_mov_b32 s37, 32
    s_branch att_retry
att_ok:
    s_lshl_b32 s26, s30, 11
    s_lshl_b32 s28, s30, 9
    s_add_u32 s26, s26, s28
    s_add_u32 s26, s26, 133120
    v_add_u32 v104, s26, v111
    v_lshlrev_b32 v105, 3, v1
    v_add_u32 v105, s26, v105
    v_mov_b32 v81, v88
    s_cmp_eq_u32 s31, 1
    s_cbranch_scc1 att_kernel_m6
    ds_write_b128 v104, v[72:75]
    ds_write_b128 v104, v[76:79] offset:1024
    ds_write_b64 v105, v[80:81] offset:2048
    s_waitcnt lgkmcnt(0)
    s_barrier
    s_branch att_fin
att_kernel_m6:
    s_barrier
    ds_read_b128 v[40:43], v104
    ds_read_b128 v[44:47], v104 offset:1024
    ds_read_b64 v[48:49], v105 offset:2048
    s_waitcnt lgkmcnt(0)
    v_min_f32 v104, v81, v49
    v_sub_f32 v105, v104, v81
    v_sub_f32 v108, v104, v49
    v_exp_f32 v105, v105
    v_exp_f32 v108, v108
    s_nop 0
    v_mul_f32 v72, v72, v105
    v_mul_f32 v73, v73, v105
    v_mul_f32 v74, v74, v105
    v_mul_f32 v75, v75, v105
    v_mul_f32 v76, v76, v105
    v_mul_f32 v77, v77, v105
    v_mul_f32 v78, v78, v105
    v_mul_f32 v79, v79, v105
    v_mul_f32 v80, v80, v105
    v_fmac_f32 v72, v40, v108
    v_fmac_f32 v73, v41, v108
    v_fmac_f32 v74, v42, v108
    v_fmac_f32 v75, v43, v108
    v_fmac_f32 v76, v44, v108
    v_fmac_f32 v77, v45, v108
    v_fmac_f32 v78, v46, v108
    v_fmac_f32 v79, v47, v108
    v_fmac_f32 v80, v48, v108
    v_rcp_f32 v104, v80
    s_nop 0
    v_mul_f32 v72, v72, v104
    v_mul_f32 v73, v73, v104
    v_mul_f32 v74, v74, v104
    v_mul_f32 v75, v75, v104
    v_mul_f32 v76, v76, v104
    v_mul_f32 v77, v77, v104
    v_mul_f32 v78, v78, v104
    v_mul_f32 v79, v79, v104
    v_cvt_pk_bf16_f32 v32, v72, v73
    v_cvt_pk_bf16_f32 v33, v74, v75
    v_cvt_pk_bf16_f32 v34, v76, v77
    v_cvt_pk_bf16_f32 v35, v78, v79
    s_lshl_b32 s26, s27, 15
    s_lshl_b32 s28, s20, 10
    s_add_u32 s26, s26, s28
    s_add_u32 s26, s26, 6291456
    buffer_store_dwordx4 v[32:35], v111, s[16:19], s26 offen sc1
    s_branch att_fin
att_fin:
att_done:
    s_endpgm
att_kernel_end:
.globl wo_kernel
.p2align 8
.type wo_kernel,@function
wo_kernel:
    s_cmp_ge_u32 s2, 256
    s_cbranch_scc1 wo_kernel_done
    s_load_dwordx2 s[16:17], s[0:1], 80
    s_load_dwordx2 s[4:5], s[0:1], 16
    s_load_dwordx2 s[6:7], s[0:1], 0
    s_load_dwordx2 s[48:49], s[0:1], 32
    s_load_dwordx2 s[52:53], s[0:1], 40
    s_and_b32 s24, s2, 7
    s_lshr_b32 s25, s2, 3
    s_lshl_b32 s20, s24, 2
    s_and_b32 s26, s25, 3
    s_add_u32 s20, s20, s26
    s_lshr_b32 s21, s25, 2
    v_lshrrev_b32 v2, 6, v0
    v_and_b32 v1, 63, v0
    v_readfirstlane_b32 s22, v2
    s_nop 3
    s_add_u32 s36, s22, 4
    s_sub_u32 s37, s22, 8
    s_cmp_lt_u32 s22, 8
    s_cselect_b32 s36, s36, s37
    s_cmp_ge_u32 s22, 12
    s_cselect_b32 s22, s22, s36
    s_mul_i32 s29, s21, 8
    s_lshr_b32 s29, s29, 3
    s_mov_b32 s29, 0
    s_mul_i32 s30, s20, 65536
    s_add_u32 s30, s30, 6291456
    s_lshl_b32 s32, s21, 7
    s_cmp_lt_u32 s22, 4
    s_cbranch_scc1 wo_kernel_cons
    s_cmp_ge_u32 s22, 8
    s_cbranch_scc1 wo_kernel_wprod
    s_sub_u32 s23, s22, 4
    v_lshlrev_b32 v2, 4, v1
    s_lshr_b32 s26, s23, 1
    s_mul_i32 s34, s26, 32768
    s_and_b32 s26, s23, 1
    s_mul_i32 s26, s26, 2048
    s_add_u32 s34, s34, s26
    s_add_u32 s34, s34, s30
    s_mul_i32 s35, s23, 2048
    s_mul_i32 s38, s29, 4096
    s_add_u32 s34, s34, s38
    s_sub_u32 s38, 8, s29
    s_waitcnt lgkmcnt(0)
    s_mov_b32 s18, 18874368
    s_mov_b32 s19, 0x00020000
    s_add_u32 m0, s35, 0
    s_nop 0
    buffer_load_dwordx4 v2, s[16:19], s34 offen lds
    s_add_u32 m0, s35, 1024
    s_add_u32 s26, s34, 1024
    buffer_load_dwordx4 v2, s[16:19], s26 offen lds
    s_add_u32 s34, s34, 4096
    s_sub_u32 s38, s38, 1
    s_cmp_eq_u32 s38, 0
    s_cselect_b32 s26, 32768, 0
    s_sub_u32 s34, s34, s26
    s_add_u32 m0, s35, 16384
    s_nop 0
    buffer_load_dwordx4 v2, s[16:19], s34 offen lds
    s_add_u32 m0, s35, 17408
    s_add_u32 s26, s34, 1024
    buffer_load_dwordx4 v2, s[16:19], s26 offen lds
    s_add_u32 s34, s34, 4096
    s_sub_u32 s38, s38, 1
    s_cmp_eq_u32 s38, 0
    s_cselect_b32 s26, 32768, 0
    s_sub_u32 s34, s34, s26
    s_add_u32 m0, s35, 32768
    s_nop 0
    buffer_load_dwordx4 v2, s[16:19], s34 offen lds
    s_add_u32 m0, s35, 33792
    s_add_u32 s26, s34, 1024
    buffer_load_dwordx4 v2, s[16:19], s26 offen lds
    s_add_u32 s34, s34, 4096
    s_sub_u32 s38, s38, 1
    s_cmp_eq_u32 s38, 0
    s_cselect_b32 s26, 32768, 0
    s_sub_u32 s34, s34, s26
    s_add_u32 m0, s35, 49152
    s_nop 0
    buffer_load_dwordx4 v2, s[16:19], s34 offen lds
    s_add_u32 m0, s35, 50176
    s_add_u32 s26, s34, 1024
    buffer_load_dwordx4 v2, s[16:19], s26 offen lds
    s_add_u32 s34, s34, 4096
    s_sub_u32 s38, s38, 1
    s_cmp_eq_u32 s38, 0
    s_cselect_b32 s26, 32768, 0
    s_sub_u32 s34, s34, s26
    s_waitcnt vmcnt(6)
    s_barrier
    s_add_u32 m0, s35, 65536
    s_nop 0
    buffer_load_dwordx4 v2, s[16:19], s34 offen lds
    s_add_u32 m0, s35, 66560
    s_add_u32 s26, s34, 1024
    buffer_load_dwordx4 v2, s[16:19], s26 offen lds
    s_add_u32 s34, s34, 4096
    s_sub_u32 s38, s38, 1
    s_cmp_eq_u32 s38, 0
    s_cselect_b32 s26, 32768, 0
    s_sub_u32 s34, s34, s26
    s_waitcnt vmcnt(6)
    s_barrier
    s_add_u32 m0, s35, 81920
    s_nop 0
    buffer_load_dwordx4 v2, s[16:19], s34 offen lds
    s_add_u32 m0, s35, 82944
    s_add_u32 s26, s34, 1024
    buffer_load_dwordx4 v2, s[16:19], s26 offen lds
    s_add_u32 s34, s34, 4096
    s_sub_u32 s38, s38, 1
    s_cmp_eq_u32 s38, 0
    s_cselect_b32 s26, 32768, 0
    s_sub_u32 s34, s34, s26
    s_waitcnt vmcnt(6)
    s_barrier
    s_add_u32 m0, s35, 98304
    s_nop 0
    buffer_load_dwordx4 v2, s[16:19], s34 offen lds
    s_add_u32 m0, s35, 99328
    s_add_u32 s26, s34, 1024
    buffer_load_dwordx4 v2, s[16:19], s26 offen lds
    s_add_u32 s34, s34, 4096
    s_sub_u32 s38, s38, 1
    s_cmp_eq_u32 s38, 0
    s_cselect_b32 s26, 32768, 0
    s_sub_u32 s34, s34, s26
    s_waitcnt vmcnt(6)
    s_barrier
    s_add_u32 m0, s35, 114688
    s_nop 0
    buffer_load_dwordx4 v2, s[16:19], s34 offen lds
    s_add_u32 m0, s35, 115712
    s_add_u32 s26, s34, 1024
    buffer_load_dwordx4 v2, s[16:19], s26 offen lds
    s_add_u32 s34, s34, 4096
    s_sub_u32 s38, s38, 1
    s_cmp_eq_u32 s38, 0
    s_cselect_b32 s26, 32768, 0
    s_sub_u32 s34, s34, s26
    s_waitcnt vmcnt(6)
    s_barrier
    s_waitcnt vmcnt(4)
    s_barrier
    s_waitcnt vmcnt(2)
    s_barrier
    s_waitcnt vmcnt(0)
    s_barrier
    s_endpgm
wo_kernel_wprod:
    s_sub_u32 s23, s22, 8
    v_lshrrev_b32 v3, 3, v1
    v_and_b32 v4, 7, v1
    v_bfe_u32 v5, v1, 4, 1
    v_lshlrev_b32 v5, 2, v5
    v_xor_b32 v4, v4, v5
    v_lshlrev_b32 v4, 4, v4
    s_mov_b32 s26, 1024
    v_mul_lo_u32 v3, v3, s26
    v_add_u32 v3, v3, v4
    s_mul_i32 s36, s23, 16384
    s_add_u32 s36, s36, s32
    s_mul_i32 s37, s23, 2048
    s_add_u32 s37, s37, 8192
    s_mul_i32 s39, s29, 65536
    s_add_u32 s36, s36, s39
    s_sub_u32 s38, 8, s29
    s_waitcnt lgkmcnt(0)
    s_mov_b32 s8, s4
    s_mov_b32 s9, s5
    s_mov_b32 s10, 524288
    s_mov_b32 s11, 0x00020000
    v_mov_b32 v28, 0
    v_mov_b32 v29, 131200
    s_mov_b32 s42, 0
    ds_write_b32 v29, v28
    s_waitcnt lgkmcnt(0)
    s_add_u32 m0, s37, 0
    s_nop 0
    buffer_load_dwordx4 v3, s[8:11], s36 offen lds
    s_add_u32 m0, s37, 1024
    s_add_u32 s26, s36, 8192
    buffer_load_dwordx4 v3, s[8:11], s26 offen lds
    s_add_u32 s36, s36, 65536
    s_sub_u32 s38, s38, 1
    s_cmp_eq_u32 s38, 0
    s_cselect_b32 s27, 524288, 0
    s_sub_u32 s36, s36, s27
    s_add_u32 m0, s37, 16384
    s_nop 0
    buffer_load_dwordx4 v3, s[8:11], s36 offen lds
    s_add_u32 m0, s37, 17408
    s_add_u32 s26, s36, 8192
    buffer_load_dwordx4 v3, s[8:11], s26 offen lds
    s_add_u32 s36, s36, 65536
    s_sub_u32 s38, s38, 1
    s_cmp_eq_u32 s38, 0
    s_cselect_b32 s27, 524288, 0
    s_sub_u32 s36, s36, s27
    s_add_u32 m0, s37, 32768
    s_nop 0
    buffer_load_dwordx4 v3, s[8:11], s36 offen lds
    s_add_u32 m0, s37, 33792
    s_add_u32 s26, s36, 8192
    buffer_load_dwordx4 v3, s[8:11], s26 offen lds
    s_add_u32 s36, s36, 65536
    s_sub_u32 s38, s38, 1
    s_cmp_eq_u32 s38, 0
    s_cselect_b32 s27, 524288, 0
    s_sub_u32 s36, s36, s27
    s_add_u32 m0, s37, 49152
    s_nop 0
    buffer_load_dwordx4 v3, s[8:11], s36 offen lds
    s_add_u32 m0, s37, 50176
    s_add_u32 s26, s36, 8192
    buffer_load_dwordx4 v3, s[8:11], s26 offen lds
    s_add_u32 s36, s36, 65536
    s_sub_u32 s38, s38, 1
    s_cmp_eq_u32 s38, 0
    s_cselect_b32 s27, 524288, 0
    s_sub_u32 s36, s36, s27
    s_waitcnt vmcnt(6)
    s_barrier
    s_add_u32 m0, s37, 65536
    s_nop 0
    buffer_load_dwordx4 v3, s[8:11], s36 offen lds
    s_add_u32 m0, s37, 66560
    s_add_u32 s26, s36, 8192
    buffer_load_dwordx4 v3, s[8:11], s26 offen lds
    s_add_u32 s36, s36, 65536
    s_sub_u32 s38, s38, 1
    s_cmp_eq_u32 s38, 0
    s_cselect_b32 s27, 524288, 0
    s_sub_u32 s36, s36, s27
    s_waitcnt vmcnt(6)
    s_barrier
    s_mov_b32 s50, 1835008
    s_mov_b32 s51, 0x00020000
    s_and_b32 s40, s2, 7
    s_lshr_b32 s41, s40, 1
    s_mul_i32 s41, s41, 28
    s_add_u32 s41, s41, s25
    s_and_b32 s40, s40, 1
    s_mul_i32 s40, s40, 112
    s_add_u32 s41, s41, s40
    s_min_u32 s41, s41, 223
    s_lshl_b32 s43, s41, 4
    s_mul_i32 s44, s23, 458752
    s_add_u32 s40, s43, s44
    v_mul_u32_u24 v30, 3584, v1
    buffer_load_dwordx4 v[40:43], v30, s[48:51], s40 offen
    s_add_u32 s40, s40, 229376
    buffer_load_dwordx4 v[44:47], v30, s[48:51], s40 offen
    s_mov_b32 s54, 3584
    s_mov_b32 s55, 0x00020000
    v_mov_b32 v31, 0
    buffer_load_dwordx4 v[72:75], v31, s[52:55], s43 offen
    s_add_u32 m0, s37, 81920
    s_nop 0
    buffer_load_dwordx4 v3, s[8:11], s36 offen lds
    s_add_u32 m0, s37, 82944
    s_add_u32 s26, s36, 8192
    buffer_load_dwordx4 v3, s[8:11], s26 offen lds
    s_add_u32 s36, s36, 65536
    s_sub_u32 s38, s38, 1
    s_cmp_eq_u32 s38, 0
    s_cselect_b32 s27, 524288, 0
    s_sub_u32 s36, s36, s27
    s_waitcnt vmcnt(9)
    s_barrier
    s_add_u32 m0, s37, 98304
    s_nop 0
    buffer_load_dwordx4 v3, s[8:11], s36 offen lds
    s_add_u32 m0, s37, 99328
    s_add_u32 s26, s36, 8192
    buffer_load_dwordx4 v3, s[8:11], s26 offen lds
    s_add_u32 s36, s36, 65536
    s_sub_u32 s38, s38, 1
    s_cmp_eq_u32 s38, 0
    s_cselect_b32 s27, 524288, 0
    s_sub_u32 s36, s36, s27
    s_waitcnt vmcnt(9)
    s_barrier
    s_add_u32 m0, s37, 114688
    s_nop 0
    buffer_load_dwordx4 v3, s[8:11], s36 offen lds
    s_add_u32 m0, s37, 115712
    s_add_u32 s26, s36, 8192
    buffer_load_dwordx4 v3, s[8:11], s26 offen lds
    s_add_u32 s36, s36, 65536
    s_sub_u32 s38, s38, 1
    s_cmp_eq_u32 s38, 0
    s_cselect_b32 s27, 524288, 0
    s_sub_u32 s36, s36, s27
    s_waitcnt vmcnt(9)
    s_barrier
    s_waitcnt vmcnt(4)
    s_barrier
    s_waitcnt vmcnt(2)
    s_barrier
    s_cmp_ge_u32 s25, 28
    s_cbranch_scc1 wo_kernel_cs1
    v_lshlrev_b32 v8, 16, v40
    v_and_b32 v9, 0xffff0000, v40
    v_lshlrev_b32 v16, 16, v44
    v_and_b32 v17, 0xffff0000, v44
    v_add_f32 v8, v8, v16
    v_add_f32 v9, v9, v17
    v_lshlrev_b32 v10, 16, v41
    v_and_b32 v11, 0xffff0000, v41
    v_lshlrev_b32 v16, 16, v45
    v_and_b32 v17, 0xffff0000, v45
    v_add_f32 v10, v10, v16
    v_add_f32 v11, v11, v17
    v_lshlrev_b32 v12, 16, v42
    v_and_b32 v13, 0xffff0000, v42
    v_lshlrev_b32 v16, 16, v46
    v_and_b32 v17, 0xffff0000, v46
    v_add_f32 v12, v12, v16
    v_add_f32 v13, v13, v17
    v_lshlrev_b32 v14, 16, v43
    v_and_b32 v15, 0xffff0000, v43
    v_lshlrev_b32 v16, 16, v47
    v_and_b32 v17, 0xffff0000, v47
    v_add_f32 v14, v14, v16
    v_add_f32 v15, v15, v17
    s_nop 1
    v_add_f32_dpp v8, v8, v8 row_shr:1 row_mask:0xf bank_mask:0xf
    v_add_f32_dpp v9, v9, v9 row_shr:1 row_mask:0xf bank_mask:0xf
    v_add_f32_dpp v10, v10, v10 row_shr:1 row_mask:0xf bank_mask:0xf
    v_add_f32_dpp v11, v11, v11 row_shr:1 row_mask:0xf bank_mask:0xf
    v_add_f32_dpp v12, v12, v12 row_shr:1 row_mask:0xf bank_mask:0xf
    v_add_f32_dpp v13, v13, v13 row_shr:1 row_mask:0xf bank_mask:0xf
    v_add_f32_dpp v14, v14, v14 row_shr:1 row_mask:0xf bank_mask:0xf
    v_add_f32_dpp v15, v15, v15 row_shr:1 row_mask:0xf bank_mask:0xf
    s_nop 1
    v_add_f32_dpp v8, v8, v8 row_shr:2 row_mask:0xf bank_mask:0xf
    v_add_f32_dpp v9, v9, v9 row_shr:2 row_mask:0xf bank_mask:0xf
    v_add_f32_dpp v10, v10, v10 row_shr:2 row_mask:0xf bank_mask:0xf
    v_add_f32_dpp v11, v11, v11 row_shr:2 row_mask:0xf bank_mask:0xf
    v_add_f32_dpp v12, v12, v12 row_shr:2 row_mask:0xf bank_mask:0xf
    v_add_f32_dpp v13, v13, v13 row_shr:2 row_mask:0xf bank_mask:0xf
    v_add_f32_dpp v14, v14, v14 row_shr:2 row_mask:0xf bank_mask:0xf
    v_add_f32_dpp v15, v15, v15 row_shr:2 row_mask:0xf bank_mask:0xf
    s_nop 1
    v_add_f32_dpp v8, v8, v8 row_shr:4 row_mask:0xf bank_mask:0xf
    v_add_f32_dpp v9, v9, v9 row_shr:4 row_mask:0xf bank_mask:0xf
    v_add_f32_dpp v10, v10, v10 row_shr:4 row_mask:0xf bank_mask:0xf
    v_add_f32_dpp v11, v11, v11 row_shr:4 row_mask:0xf bank_mask:0xf
    v_add_f32_dpp v12, v12, v12 row_shr:4 row_mask:0xf bank_mask:0xf
    v_add_f32_dpp v13, v13, v13 row_shr:4 row_mask:0xf bank_mask:0xf
    v_add_f32_dpp v14, v14, v14 row_shr:4 row_mask:0xf bank_mask:0xf
    v_add_f32_dpp v15, v15, v15 row_shr:4 row_mask:0xf bank_mask:0xf
    s_nop 1
    v_add_f32_dpp v8, v8, v8 row_shr:8 row_mask:0xf bank_mask:0xf
    v_add_f32_dpp v9, v9, v9 row_shr:8 row_mask:0xf bank_mask:0xf
    v_add_f32_dpp v10, v10, v10 row_shr:8 row_mask:0xf bank_mask:0xf
    v_add_f32_dpp v11, v11, v11 row_shr:8 row_mask:0xf bank_mask:0xf
    v_add_f32_dpp v12, v12, v12 row_shr:8 row_mask:0xf bank_mask:0xf
    v_add_f32_dpp v13, v13, v13 row_shr:8 row_mask:0xf bank_mask:0xf
    v_add_f32_dpp v14, v14, v14 row_shr:8 row_mask:0xf bank_mask:0xf
    v_add_f32_dpp v15, v15, v15 row_shr:8 row_mask:0xf bank_mask:0xf
    s_nop 1
    v_add_f32_dpp v8, v8, v8 row_bcast:15 row_mask:0xa bank_mask:0xf
    v_add_f32_dpp v9, v9, v9 row_bcast:15 row_mask:0xa bank_mask:0xf
    v_add_f32_dpp v10, v10, v10 row_bcast:15 row_mask:0xa bank_mask:0xf
    v_add_f32_dpp v11, v11, v11 row_bcast:15 row_mask:0xa bank_mask:0xf
    v_add_f32_dpp v12, v12, v12 row_bcast:15 row_mask:0xa bank_mask:0xf
    v_add_f32_dpp v13, v13, v13 row_bcast:15 row_mask:0xa bank_mask:0xf
    v_add_f32_dpp v14, v14, v14 row_bcast:15 row_mask:0xa bank_mask:0xf
    v_add_f32_dpp v15, v15, v15 row_bcast:15 row_mask:0xa bank_mask:0xf
    s_nop 1
    v_add_f32_dpp v8, v8, v8 row_bcast:31 row_mask:0xc bank_mask:0xf
    v_add_f32_dpp v9, v9, v9 row_bcast:31 row_mask:0xc bank_mask:0xf
    v_add_f32_dpp v10, v10, v10 row_bcast:31 row_mask:0xc bank_mask:0xf
    v_add_f32_dpp v11, v11, v11 row_bcast:31 row_mask:0xc bank_mask:0xf
    v_add_f32_dpp v12, v12, v12 row_bcast:31 row_mask:0xc bank_mask:0xf
    v_add_f32_dpp v13, v13, v13 row_bcast:31 row_mask:0xc bank_mask:0xf
    v_add_f32_dpp v14, v14, v14 row_bcast:31 row_mask:0xc bank_mask:0xf
    v_add_f32_dpp v15, v15, v15 row_bcast:31 row_mask:0xc bank_mask:0xf
    s_lshl_b32 s40, s23, 5
    s_add_u32 s40, s40, 131072
    v_mov_b32 v2, s40
    v_mov_b32 v18, 1
    s_mov_b32 exec_lo, 0
    s_mov_b32 exec_hi, 0x80000000
    ds_write_b128 v2, v[8:11]
    ds_write_b128 v2, v[12:15] offset:16
    s_waitcnt lgkmcnt(0)
    ds_add_rtn_u32 v19, v29, v18
    s_waitcnt lgkmcnt(0)
    v_readlane_b32 s42, v19, 63
    s_mov_b64 exec, -1
wo_kernel_cs1:
    s_waitcnt vmcnt(0)
    s_barrier
    s_cmp_lg_u32 s42, 3
    s_cbranch_scc1 wo_kernel_cs2
    s_mov_b32 exec_lo, 0
    s_mov_b32 exec_hi, 0x80000000
    v_mov_b32 v2, 131072
    ds_read_b128 v[40:43], v2 offset:0
    ds_read_b128 v[44:47], v2 offset:16
    ds_read_b128 v[48:51], v2 offset:32
    ds_read_b128 v[52:55], v2 offset:48
    ds_read_b128 v[56:59], v2 offset:64
    ds_read_b128 v[60:63], v2 offset:80
    ds_read_b128 v[64:67], v2 offset:96
    ds_read_b128 v[68:71], v2 offset:112
    s_waitcnt lgkmcnt(0)
    v_add_f32 v40, v40, v48
    v_add_f32 v56, v56, v64
    v_add_f32 v40, v40, v56
    v_add_f32 v41, v41, v49
    v_add_f32 v57, v57, v65
    v_add_f32 v41, v41, v57
    v_add_f32 v42, v42, v50
    v_add_f32 v58, v58, v66
    v_add_f32 v42, v42, v58
    v_add_f32 v43, v43, v51
    v_add_f32 v59, v59, v67
    v_add_f32 v43, v43, v59
    v_add_f32 v44, v44, v52
    v_add_f32 v60, v60, v68
    v_add_f32 v44, v44, v60
    v_add_f32 v45, v45, v53
    v_add_f32 v61, v61, v69
    v_add_f32 v45, v45, v61
    v_add_f32 v46, v46, v54
    v_add_f32 v62, v62, v70
    v_add_f32 v46, v46, v62
    v_add_f32 v47, v47, v55
    v_add_f32 v63, v63, v71
    v_add_f32 v47, v47, v63
    v_lshlrev_b32 v16, 16, v72
    v_and_b32 v17, 0xffff0000, v72
    v_lshlrev_b32 v18, 16, v73
    v_and_b32 v19, 0xffff0000, v73
    v_lshlrev_b32 v20, 16, v74
    v_and_b32 v21, 0xffff0000, v74
    v_lshlrev_b32 v22, 16, v75
    v_and_b32 v23, 0xffff0000, v75
    s_lshl_b32 s40, s41, 5
    s_add_u32 s40, s40, 18350080
    s_mov_b32 s18, 18874368
    s_mov_b32 s19, 0x00020000
    v_mov_b32 v2, 0
    buffer_store_dwordx4 v[40:43], v2, s[16:19], s40 offen sc1
    buffer_store_dwordx4 v[44:47], v2, s[16:19], s40 offen offset:16 sc1
    s_add_u32 s40, s40, 8192
    buffer_store_dwordx4 v[16:19], v2, s[16:19], s40 offen sc1
    buffer_store_dwordx4 v[20:23], v2, s[16:19], s40 offen offset:16 sc1
    s_mov_b64 exec, -1
wo_kernel_cs2:
    s_endpgm
wo_kernel_cons:
    s_lshr_b32 s23, s22, 1
    s_and_b32 s24, s22, 1
    v_and_b32 v3, 31, v1
    v_lshrrev_b32 v4, 5, v1
    v_lshlrev_b32 v2, 4, v1
    s_lshl_b32 s27, s20, 1
    s_add_u32 s27, s27, s23
    s_waitcnt lgkmcnt(0)
    s_mov_b32 s18, 18874368
    s_mov_b32 s19, 0x00020000
    s_cmp_lg_u32 s25, 0
    s_cbranch_scc1 wo_kernel_pcs3
    s_cmp_lg_u32 s22, 0
    s_cbranch_scc1 wo_kernel_pcs3
    s_getpc_b64 s[80:81]
wo_kernel_pc4:
    s_add_u32 s80, s80, mlp1_kernel-wo_kernel_pc4
    s_addc_u32 s81, s81, 0
    v_lshlrev_b32 v123, 7, v1
    v_min_u32 v123, mlp1_kernel_end-mlp1_kernel-4, v123
    v_mov_b32 v121, s81
    v_add_co_u32 v120, vcc, s80, v123
    s_nop 1
    v_addc_co_u32 v121, vcc, 0, v121, vcc
    global_load_dword v122, v[120:121], off
wo_kernel_pcs3:
    s_mov_b32 s12, s6
    s_mov_b32 s13, s7
    s_mov_b32 s14, 2097152
    s_mov_b32 s15, 0x00020000
    v_lshlrev_b32 v5, 10, v3
    v_lshl_add_u32 v5, v4, 3, v5
    s_lshl_b32 s28, s27, 15
    s_lshl_b32 s26, s21, 7
    s_add_u32 s28, s28, s26
    s_lshl_b32 s26, s24, 6
    s_add_u32 s28, s28, s26
    buffer_load_dwordx2 v[96:97], v5, s[12:15], s28 offen offset:0
    buffer_load_dwordx2 v[98:99], v5, s[12:15], s28 offen offset:16
    buffer_load_dwordx2 v[100:101], v5, s[12:15], s28 offen offset:32
    buffer_load_dwordx2 v[102:103], v5, s[12:15], s28 offen offset:48
    v_lshrrev_b32 v4, 5, v1
    v_lshlrev_b32 v5, 4, v1
    s_mul_i32 s26, s23, 4096
    v_add_u32 v14, s26, v5
    v_bfe_u32 v7, v1, 2, 2
    v_lshl_add_u32 v8, v4, 2, v7
    v_mul_u32_u24 v8, 128, v8
    v_lshrrev_b32 v7, 1, v7
    v_lshl_add_u32 v8, v7, 6, v8
    v_bfe_u32 v7, v1, 4, 1
    v_lshl_add_u32 v8, v7, 5, v8
    v_and_b32 v7, 3, v1
    v_lshl_add_u32 v8, v7, 3, v8
    v_add_u32 v8, 8192, v8
    s_lshl_b32 s26, s24, 6
    v_xor_b32 v15, s26, v8
    v_mov_b32 v16, v14
    v_mov_b32 v17, v15
    v_mov_b32 v18, v16
    v_mov_b32 v19, v17
    v_mov_b32 v56, 0
    v_mov_b32 v57, 0
    v_mov_b32 v58, 0
    v_mov_b32 v59, 0
    v_mov_b32 v60, 0
    v_mov_b32 v61, 0
    v_mov_b32 v62, 0
    v_mov_b32 v63, 0
    v_mov_b32 v64, 0
    v_mov_b32 v65, 0
    v_mov_b32 v66, 0
    v_mov_b32 v67, 0
    v_mov_b32 v68, 0
    v_mov_b32 v69, 0
    v_mov_b32 v70, 0
    v_mov_b32 v71, 0
    s_mov_b32 s34, 0
    s_mov_b32 s35, 0
    s_barrier
    ds_read_b128 v[24:27], v18 offset:0
    ds_read_b64_tr_b16 v[28:29], v19 offset:0
    ds_read_b64_tr_b16 v[30:31], v19 offset:1024
    ds_read_b128 v[32:35], v18 offset:1024
    ds_read_b64_tr_b16 v[36:37], v19 offset:2048
    ds_read_b64_tr_b16 v[38:39], v19 offset:3072
    ds_read_b128 v[40:43], v18 offset:2048
    ds_read_b64_tr_b16 v[44:45], v19 offset:4096
    ds_read_b64_tr_b16 v[46:47], v19 offset:5120
    ds_read_b128 v[48:51], v18 offset:3072
    ds_read_b64_tr_b16 v[52:53], v19 offset:6144
    ds_read_b64_tr_b16 v[54:55], v19 offset:7168
wo_kernel_var0:
wo_kernel_loop0:
    s_add_u32 s34, s34, 16384
    s_cmp_eq_u32 s34, 131072
    s_cselect_b32 s34, 0, s34
    v_add_u32 v20, s34, v16
    v_add_u32 v21, s34, v17
    s_barrier
    s_waitcnt lgkmcnt(9)
    v_mfma_f32_32x32x16_bf16 v[56:71], v[28:31], v[24:27], v[56:71]
    ds_read_b64_tr_b16 v[28:29], v21 offset:0
    ds_read_b64_tr_b16 v[30:31], v21 offset:1024
    ds_read_b128 v[24:27], v20 offset:0
    s_waitcnt lgkmcnt(9)
    v_mfma_f32_32x32x16_bf16 v[56:71], v[36:39], v[32:35], v[56:71]
    ds_read_b64_tr_b16 v[36:37], v21 offset:2048
    ds_read_b64_tr_b16 v[38:39], v21 offset:3072
    ds_read_b128 v[32:35], v20 offset:1024
    s_waitcnt lgkmcnt(9)
    v_mfma_f32_32x32x16_bf16 v[56:71], v[44:47], v[40:43], v[56:71]
    ds_read_b64_tr_b16 v[44:45], v21 offset:4096
    ds_read_b64_tr_b16 v[46:47], v21 offset:5120
    ds_read_b128 v[40:43], v20 offset:2048
    s_waitcnt lgkmcnt(9)
    v_mfma_f32_32x32x16_bf16 v[56:71], v[52:55], v[48:51], v[56:71]
    ds_read_b64_tr_b16 v[52:53], v21 offset:6144
    ds_read_b64_tr_b16 v[54:55], v21 offset:7168
    ds_read_b128 v[48:51], v20 offset:3072
    v_mov_b32 v18, v20
    v_mov_b32 v19, v21
    s_add_u32 s35, s35, 1
    s_cmp_lt_u32 s35, 7
    s_cbranch_scc1 wo_kernel_loop0
    s_waitcnt lgkmcnt(9)
    v_mfma_f32_32x32x16_bf16 v[56:71], v[28:31], v[24:27], v[56:71]
    s_waitcnt lgkmcnt(6)
    v_mfma_f32_32x32x16_bf16 v[56:71], v[36:39], v[32:35], v[56:71]
    s_waitcnt lgkmcnt(3)
    v_mfma_f32_32x32x16_bf16 v[56:71], v[44:47], v[40:43], v[56:71]
    s_waitcnt lgkmcnt(0)
    v_mfma_f32_32x32x16_bf16 v[56:71], v[52:55], v[48:51], v[56:71]
wo_kernel_epi:
    s_waitcnt vmcnt(0)
    s_nop 11
    v_lshlrev_b32 v112, 16, v96
    v_and_b32 v113, 0xffff0000, v96
    v_add_f32 v56, v56, v112
    v_add_f32 v57, v57, v113
    v_lshlrev_b32 v112, 16, v97
    v_and_b32 v113, 0xffff0000, v97
    v_add_f32 v58, v58, v112
    v_add_f32 v59, v59, v113
    v_lshlrev_b32 v112, 16, v98
    v_and_b32 v113, 0xffff0000, v98
    v_add_f32 v60, v60, v112
    v_add_f32 v61, v61, v113
    v_lshlrev_b32 v112, 16, v99
    v_and_b32 v113, 0xffff0000, v99
    v_add_f32 v62, v62, v112
    v_add_f32 v63, v63, v113
    v_lshlrev_b32 v112, 16, v100
    v_and_b32 v113, 0xffff0000, v100
    v_add_f32 v64, v64, v112
    v_add_f32 v65, v65, v113
    v_lshlrev_b32 v112, 16, v101
    v_and_b32 v113, 0xffff0000, v101
    v_add_f32 v66, v66, v112
    v_add_f32 v67, v67, v113
    v_lshlrev_b32 v112, 16, v102
    v_and_b32 v113, 0xffff0000, v102
    v_add_f32 v68, v68, v112
    v_add_f32 v69, v69, v113
    v_lshlrev_b32 v112, 16, v103
    v_and_b32 v113, 0xffff0000, v103
    v_add_f32 v70, v70, v112
    v_add_f32 v71, v71, v113
    v_cvt_pk_bf16_f32 v116, v56, v57
    v_cvt_pk_bf16_f32 v117, v58, v59
    v_cvt_pk_bf16_f32 v118, v60, v61
    v_cvt_pk_bf16_f32 v119, v62, v63
    v_cvt_pk_bf16_f32 v120, v64, v65
    v_cvt_pk_bf16_f32 v121, v66, v67
    v_cvt_pk_bf16_f32 v122, v68, v69
    v_cvt_pk_bf16_f32 v123, v70, v71
    s_lshl_b32 s28, s27, 15
    s_lshl_b32 s26, s21, 12
    s_add_u32 s28, s28, s26
    s_lshl_b32 s26, s24, 11
    s_add_u32 s28, s28, s26
    s_add_u32 s28, s28, 8388608
    buffer_store_dwordx4 v[116:119], v2, s[16:19], s28 offen sc1
    buffer_store_dwordx4 v[120:123], v2, s[16:19], s28 offen offset:1024 sc1
    v_add_f32 v112, v56, v57
    v_mul_f32 v113, v56, v56
    v_fmac_f32 v113, v57, v57
    v_add_f32 v114, v58, v59
    v_mul_f32 v115, v58, v58
    v_fmac_f32 v115, v59, v59
    v_add_f32 v112, v112, v60
    v_fmac_f32 v113, v60, v60
    v_add_f32 v112, v112, v61
    v_fmac_f32 v113, v61, v61
    v_add_f32 v114, v114, v62
    v_fmac_f32 v115, v62, v62
    v_add_f32 v114, v114, v63
    v_fmac_f32 v115, v63, v63
    v_add_f32 v112, v112, v64
    v_fmac_f32 v113, v64, v64
    v_add_f32 v112, v112, v65
    v_fmac_f32 v113, v65, v65
    v_add_f32 v114, v114, v66
    v_fmac_f32 v115, v66, v66
    v_add_f32 v114, v114, v67
    v_fmac_f32 v115, v67, v67
    v_add_f32 v112, v112, v68
    v_fmac_f32 v113, v68, v68
    v_add_f32 v112, v112, v69
    v_fmac_f32 v113, v69, v69
    v_add_f32 v114, v114, v70
    v_fmac_f32 v115, v70, v70
    v_add_f32 v114, v114, v71
    v_fmac_f32 v115, v71, v71
    v_add_f32 v112, v112, v114
    v_add_f32 v113, v113, v115
    v_mov_b32 v114, v112
    v_mov_b32 v115, v113
    v_lshlrev_b32 v5, 7, v3
    s_lshl_b32 s28, s27, 12
    v_permlane32_swap_b32 v112, v114
    v_permlane32_swap_b32 v113, v115
    s_lshl_b32 s26, s21, 4
    s_add_u32 s28, s28, s26
    v_add_f32 v112, v112, v114
    v_add_f32 v113, v113, v115
    s_lshl_b32 s26, s24, 3
    s_add_u32 s28, s28, s26
    s_add_u32 s28, s28, 17825792
    s_mov_b32 exec_hi, 0
    buffer_store_dwordx2 v[112:113], v5, s[16:19], s28 offen
wo_kernel_done:
    s_endpgm
wo_kernel_end:
.globl mlp1_kernel
.p2align 8
.type mlp1_kernel,@function
mlp1_kernel:
    s_cmp_ge_u32 s2, 224
    s_cbranch_scc1 mlp1_kernel_done
    s_load_dwordx2 s[16:17], s[0:1], 80
    s_load_dwordx4 s[4:7], s[0:1], 32
    s_load_dwordx2 s[44:45], s[0:1], 48
    s_and_b32 s24, s2, 7
    s_lshr_b32 s25, s2, 3
    s_lshr_b32 s20, s24, 1
    s_lshl_b32 s20, s20, 2
    s_and_b32 s26, s25, 3
    s_add_u32 s20, s20, s26
    s_and_b32 s21, s24, 1
    s_mul_i32 s21, s21, 7
    s_lshr_b32 s29, s25, 2
    s_add_u32 s21, s21, s29
    v_lshrrev_b32 v2, 6, v0
    v_and_b32 v1, 63, v0
    v_readfirstlane_b32 s22, v2
    s_nop 3
    s_add_u32 s36, s22, 4
    s_sub_u32 s37, s22, 8
    s_cmp_lt_u32 s22, 8
    s_cselect_b32 s36, s36, s37
    s_cmp_ge_u32 s22, 12
    s_cselect_b32 s22, s22, s36
    s_lshl_b32 s30, s20, 17
    s_add_u32 s30, s30, 8388608
    s_lshl_b32 s32, s21, 8
    s_cmp_lt_u32 s22, 4
    s_cbranch_scc1 mlp1_kernel_cons
    s_cmp_ge_u32 s22, 8
    s_cbranch_scc1 mlp1_kernel_wprod
    s_sub_u32 s23, s22, 4
    v_lshlrev_b32 v2, 4, v1
    s_mul_i32 s34, s23, 32768
    s_add_u32 s34, s34, s30
    s_mul_i32 s35, s23, 4096
    s_mul_i32 s38, s29, 4096
    s_add_u32 s34, s34, s38
    s_sub_u32 s38, 8, s29
    s_waitcnt lgkmcnt(0)
    s_mov_b32 s18, 18874368
    s_mov_b32 s19, 0x00020000
    v_and_b32 v3, 31, v1
    v_lshrrev_b32 v4, 5, v1
    v_lshlrev_b32 v6, 7, v3
    v_lshl_add_u32 v6, v4, 6, v6
    s_lshl_b32 s27, s20, 2
    s_add_u32 s27, s27, s23
    s_lshl_b32 s31, s27, 12
    s_add_u32 s31, s31, 17825792
    buffer_load_dwordx4 v[64:67], v6, s[16:19], s31 offen offset:0
    buffer_load_dwordx4 v[68:71], v6, s[16:19], s31 offen offset:16
    buffer_load_dwordx4 v[72:75], v6, s[16:19], s31 offen offset:32
    buffer_load_dwordx4 v[76:79], v6, s[16:19], s31 offen offset:48
    s_add_u32 m0, s35, 0
    s_nop 0
    buffer_load_dwordx4 v2, s[16:19], s34 offen lds
    s_add_u32 m0, s35, 1024
    s_add_u32 s26, s34, 1024
    buffer_load_dwordx4 v2, s[16:19], s26 offen lds
    s_add_u32 m0, s35, 2048
    s_add_u32 s26, s34, 2048
    buffer_load_dwordx4 v2, s[16:19], s26 offen lds
    s_add_u32 m0, s35, 3072
    s_add_u32 s26, s34, 3072
    buffer_load_dwordx4 v2, s[16:19], s26 offen lds
    s_add_u32 s34, s34, 4096
    s_sub_u32 s38, s38, 1
    s_cmp_eq_u32 s38, 0
    s_cselect_b32 s26, 32768, 0
    s_sub_u32 s34, s34, s26
    s_waitcnt vmcnt(4)
    v_add_f32 v64, v64, v66
    v_add_f32 v65, v65, v67
    v_add_f32 v64, v64, v68
    v_add_f32 v65, v65, v69
    v_add_f32 v64, v64, v70
    v_add_f32 v65, v65, v71
    v_add_f32 v64, v64, v72
    v_add_f32 v65, v65, v73
    v_add_f32 v64, v64, v74
    v_add_f32 v65, v65, v75
    v_add_f32 v64, v64, v76
    v_add_f32 v65, v65, v77
    v_add_f32 v64, v64, v78
    v_add_f32 v65, v65, v79
    v_mov_b32 v66, v64
    v_mov_b32 v67, v65
    s_nop 1
    v_permlane32_swap_b32 v64, v66
    v_permlane32_swap_b32 v65, v67
    s_nop 0
    v_add_f32 v64, v64, v66
    v_add_f32 v65, v65, v67
    v_mul_f32 v64, 0x3b000000, v64
    v_mul_f32 v65, 0x3b000000, v65
    v_fma_f32 v65, -v64, v64, v65
    v_max_f32 v65, 0, v65
    v_add_f32 v66, 0x3727c5ac, v65
    v_rsq_f32 v67, v66
    v_sub_f32 v73, 0, v64
    v_mul_f32 v68, v67, v67
    v_mul_f32 v68, v68, v65
    v_add_f32 v68, 0x3727c5ac, v68
    v_rsq_f32 v68, v68
    s_nop 0
    v_mul_f32 v69, v67, v68
    v_rcp_f32 v72, v69
    v_mul_f32 v74, 0xc0135761, v69
    v_mul_f32 v75, v69, v69
    v_mul_f32 v75, v75, v69
    v_mul_f32 v75, 0xbdd2d3e8, v75
    v_lshlrev_b32 v5, 4, v3
    s_lshl_b32 s26, s23, 9
    s_add_u32 s26, s26, 132096
    v_add_u32 v5, s26, v5
    ds_write_b128 v5, v[72:75]
    s_waitcnt lgkmcnt(0)
    s_barrier
    s_add_u32 m0, s35, 32768
    s_nop 0
    buffer_load_dwordx4 v2, s[16:19], s34 offen lds
    s_add_u32 m0, s35, 33792
    s_add_u32 s26, s34, 1024
    buffer_load_dwordx4 v2, s[16:19], s26 offen lds
    s_add_u32 m0, s35, 34816
    s_add_u32 s26, s34, 2048
    buffer_load_dwordx4 v2, s[16:19], s26 offen lds
    s_add_u32 m0, s35, 35840
    s_add_u32 s26, s34, 3072
    buffer_load_dwordx4 v2, s[16:19], s26 offen lds
    s_add_u32 s34, s34, 4096
    s_sub_u32 s38, s38, 1
    s_cmp_eq_u32 s38, 0
    s_cselect_b32 s26, 32768, 0
    s_sub_u32 s34, s34, s26
    s_waitcnt vmcnt(4)
    s_barrier
    s_add_u32 m0, s35, 65536
    s_nop 0
    buffer_load_dwordx4 v2, s[16:19], s34 offen lds
    s_add_u32 m0, s35, 66560
    s_add_u32 s26, s34, 1024
    buffer_load_dwordx4 v2, s[16:19], s26 offen lds
    s_add_u32 m0, s35, 67584
    s_add_u32 s26, s34, 2048
    buffer_load_dwordx4 v2, s[16:19], s26 offen lds
    s_add_u32 m0, s35, 68608
    s_add_u32 s26, s34, 3072
    buffer_load_dwordx4 v2, s[16:19], s26 offen lds
    s_add_u32 s34, s34, 4096
    s_sub_u32 s38, s38, 1
    s_cmp_eq_u32 s38, 0
    s_cselect_b32 s26, 32768, 0
    s_sub_u32 s34, s34, s26
    s_waitcnt vmcnt(4)
    s_barrier
    s_add_u32 m0, s35, 98304
    s_nop 0
    buffer_load_dwordx4 v2, s[16:19], s34 offen lds
    s_add_u32 m0, s35, 99328
    s_add_u32 s26, s34, 1024
    buffer_load_dwordx4 v2, s[16:19], s26 offen lds
    s_add_u32 m0, s35, 100352
    s_add_u32 s26, s34, 2048
    buffer_load_dwordx4 v2, s[16:19], s26 offen lds
    s_add_u32 m0, s35, 101376
    s_add_u32 s26, s34, 3072
    buffer_load_dwordx4 v2, s[16:19], s26 offen lds
    s_add_u32 s34, s34, 4096
    s_sub_u32 s38, s38, 1
    s_cmp_eq_u32 s38, 0
    s_cselect_b32 s26, 32768, 0
    s_sub_u32 s34, s34, s26
    s_waitcnt vmcnt(4)
    s_barrier
    s_add_u32 m0, s35, 0
    s_nop 0
    buffer_load_dwordx4 v2, s[16:19], s34 offen lds
    s_add_u32 m0, s35, 1024
    s_add_u32 s26, s34, 1024
    buffer_load_dwordx4 v2, s[16:19], s26 offen lds
    s_add_u32 m0, s35, 2048
    s_add_u32 s26, s34, 2048
    buffer_load_dwordx4 v2, s[16:19], s26 offen lds
    s_add_u32 m0, s35, 3072
    s_add_u32 s26, s34, 3072
    buffer_load_dwordx4 v2, s[16:19], s26 offen lds
    s_add_u32 s34, s34, 4096
    s_sub_u32 s38, s38, 1
    s_cmp_eq_u32 s38, 0
    s_cselect_b32 s26, 32768, 0
    s_sub_u32 s34, s34, s26
    s_waitcnt vmcnt(4)
    s_barrier
    s_add_u32 m0, s35, 32768
    s_nop 0
    buffer_load_dwordx4 v2, s[16:19], s34 offen lds
    s_add_u32 m0, s35, 33792
    s_add_u32 s26, s34, 1024
    buffer_load_dwordx4 v2, s[16:19], s26 offen lds
    s_add_u32 m0, s35, 34816
    s_add_u32 s26, s34, 2048
    buffer_load_dwordx4 v2, s[16:19], s26 offen lds
    s_add_u32 m0, s35, 35840
    s_add_u32 s26, s34, 3072
    buffer_load_dwordx4 v2, s[16:19], s26 offen lds
    s_add_u32 s34, s34, 4096
    s_sub_u32 s38, s38, 1
    s_cmp_eq_u32 s38, 0
    s_cselect_b32 s26, 32768, 0
    s_sub_u32 s34, s34, s26
    s_waitcnt vmcnt(4)
    s_barrier
    s_add_u32 m0, s35, 65536
    s_nop 0
    buffer_load_dwordx4 v2, s[16:19], s34 offen lds
    s_add_u32 m0, s35, 66560
    s_add_u32 s26, s34, 1024
    buffer_load_dwordx4 v2, s[16:19], s26 offen lds
    s_add_u32 m0, s35, 67584
    s_add_u32 s26, s34, 2048
    buffer_load_dwordx4 v2, s[16:19], s26 offen lds
    s_add_u32 m0, s35, 68608
    s_add_u32 s26, s34, 3072
    buffer_load_dwordx4 v2, s[16:19], s26 offen lds
    s_add_u32 s34, s34, 4096
    s_sub_u32 s38, s38, 1
    s_cmp_eq_u32 s38, 0
    s_cselect_b32 s26, 32768, 0
    s_sub_u32 s34, s34, s26
    s_waitcnt vmcnt(4)
    s_barrier
    s_add_u32 m0, s35, 98304
    s_nop 0
    buffer_load_dwordx4 v2, s[16:19], s34 offen lds
    s_add_u32 m0, s35, 99328
    s_add_u32 s26, s34, 1024
    buffer_load_dwordx4 v2, s[16:19], s26 offen lds
    s_add_u32 m0, s35, 100352
    s_add_u32 s26, s34, 2048
    buffer_load_dwordx4 v2, s[16:19], s26 offen lds
    s_add_u32 m0, s35, 101376
    s_add_u32 s26, s34, 3072
    buffer_load_dwordx4 v2, s[16:19], s26 offen lds
    s_add_u32 s34, s34, 4096
    s_sub_u32 s38, s38, 1
    s_cmp_eq_u32 s38, 0
    s_cselect_b32 s26, 32768, 0
    s_sub_u32 s34, s34, s26
    s_waitcnt vmcnt(4)
    s_barrier
    s_waitcnt vmcnt(0)
    s_barrier
    s_mov_b32 s46, 1835008
    s_mov_b32 s47, 0x00020000
    v_lshlrev_b32 v7, 7, v1
    s_lshl_b32 s26, s25, 2
    s_add_u32 s26, s26, s23
    s_lshl_b32 s26, s26, 14
    buffer_load_dword v8, v7, s[44:47], s26 offen
    s_add_u32 s26, s26, 8192
    buffer_load_dword v8, v7, s[44:47], s26 offen
    s_endpgm
mlp1_kernel_wprod:
    s_sub_u32 s23, s22, 8
    v_lshrrev_b32 v3, 4, v1
    v_and_b32 v5, 15, v1
    v_lshlrev_b32 v4, 2, v3
    v_xor_b32 v5, v5, v4
    s_mov_b32 s26, 3584
    v_mul_lo_u32 v3, v3, s26
    v_lshl_add_u32 v3, v5, 4, v3
    s_mul_i32 s36, s23, 57344
    s_add_u32 s36, s36, s32
    s_mul_i32 s37, s23, 4096
    s_add_u32 s37, s37, 16384
    s_mul_i32 s39, s29, 229376
    s_add_u32 s36, s36, s39
    s_sub_u32 s38, 8, s29
    s_waitcnt lgkmcnt(0)
    s_mov_b32 s8, s4
    s_mov_b32 s9, s5
    s_mov_b32 s10, 1835008
    s_mov_b32 s11, 0x00020000
    v_and_b32 v9, 31, v1
    v_lshlrev_b32 v11, 2, v9
    s_mov_b32 s18, 18874368
    s_mov_b32 s19, 0x00020000
    s_lshl_b32 s26, s21, 9
    s_lshl_b32 s27, s23, 7
    s_add_u32 s26, s26, s27
    s_add_u32 s26, s26, 18350080
    buffer_load_dword v24, v11, s[16:19], s26 offen
    s_add_u32 s26, s26, 8192
    buffer_load_dword v20, v11, s[16:19], s26 offen
    s_add_u32 m0, s37, 0
    s_nop 0
    buffer_load_dwordx4 v3, s[8:11], s36 offen lds
    s_add_u32 m0, s37, 1024
    s_add_u32 s26, s36, 14336
    buffer_load_dwordx4 v3, s[8:11], s26 offen lds
    s_add_u32 m0, s37, 2048
    s_add_u32 s26, s36, 28672
    buffer_load_dwordx4 v3, s[8:11], s26 offen lds
    s_add_u32 m0, s37, 3072
    s_add_u32 s26, s36, 43008
    buffer_load_dwordx4 v3, s[8:11], s26 offen lds
    s_add_u32 s36, s36, 229376
    s_sub_u32 s38, s38, 1
    s_cmp_eq_u32 s38, 0
    s_cselect_b32 s27, 1835008, 0
    s_sub_u32 s36, s36, s27
    s_waitcnt vmcnt(4)
    s_lshl_b32 s26, s23, 7
    s_add_u32 s26, s26, 131072
    v_add_u32 v5, s26, v11
    ds_write_b32 v5, v20 offset:512
    ds_write_b32 v5, v24
    s_waitcnt lgkmcnt(0)
    s_barrier
    s_add_u32 m0, s37, 32768
    s_nop 0
    buffer_load_dwordx4 v3, s[8:11], s36 offen lds
    s_add_u32 m0, s37, 33792
    s_add_u32 s26, s36, 14336
    buffer_load_dwordx4 v3, s[8:11], s26 offen lds
    s_add_u32 m0, s37, 34816
    s_add_u32 s26, s36, 28672
    buffer_load_dwordx4 v3, s[8:11], s26 offen lds
    s_add_u32 m0, s37, 35840
    s_add_u32 s26, s36, 43008
    buffer_load_dwordx4 v3, s[8:11], s26 offen lds
    s_add_u32 s36, s36, 229376
    s_sub_u32 s38, s38, 1
    s_cmp_eq_u32 s38, 0
    s_cselect_b32 s27, 1835008, 0
    s_sub_u32 s36, s36, s27
    s_waitcnt vmcnt(4)
    s_barrier
    s_add_u32 m0, s37, 65536
    s_nop 0
    buffer_load_dwordx4 v3, s[8:11], s36 offen lds
    s_add_u32 m0, s37, 66560
    s_add_u32 s26, s36, 14336
    buffer_load_dwordx4 v3, s[8:11], s26 offen lds
    s_add_u32 m0, s37, 67584
    s_add_u32 s26, s36, 28672
    buffer_load_dwordx4 v3, s[8:11], s26 offen lds
    s_add_u32 m0, s37, 68608
    s_add_u32 s26, s36, 43008
    buffer_load_dwordx4 v3, s[8:11], s26 offen lds
    s_add_u32 s36, s36, 229376
    s_sub_u32 s38, s38, 1
    s_cmp_eq_u32 s38, 0
    s_cselect_b32 s27, 1835008, 0
    s_sub_u32 s36, s36, s27
    s_waitcnt vmcnt(4)
    s_barrier
    s_add_u32 m0, s37, 98304
    s_nop 0
    buffer_load_dwordx4 v3, s[8:11], s36 offen lds
    s_add_u32 m0, s37, 99328
    s_add_u32 s26, s36, 14336
    buffer_load_dwordx4 v3, s[8:11], s26 offen lds
    s_add_u32 m0, s37, 100352
    s_add_u32 s26, s36, 28672
    buffer_load_dwordx4 v3, s[8:11], s26 offen lds
    s_add_u32 m0, s37, 101376
    s_add_u32 s26, s36, 43008
    buffer_load_dwordx4 v3, s[8:11], s26 offen lds
    s_add_u32 s36, s36, 229376
    s_sub_u32 s38, s38, 1
    s_cmp_eq_u32 s38, 0
    s_cselect_b32 s27, 1835008, 0
    s_sub_u32 s36, s36, s27
    s_waitcnt vmcnt(4)
    s_barrier
    s_add_u32 m0, s37, 0
    s_nop 0
    buffer_load_dwordx4 v3, s[8:11], s36 offen lds
    s_add_u32 m0, s37, 1024
    s_add_u32 s26, s36, 14336
    buffer_load_dwordx4 v3, s[8:11], s26 offen lds
    s_add_u32 m0, s37, 2048
    s_add_u32 s26, s36, 28672
    buffer_load_dwordx4 v3, s[8:11], s26 offen lds
    s_add_u32 m0, s37, 3072
    s_add_u32 s26, s36, 43008
    buffer_load_dwordx4 v3, s[8:11], s26 offen lds
    s_add_u32 s36, s36, 229376
    s_sub_u32 s38, s38, 1
    s_cmp_eq_u32 s38, 0
    s_cselect_b32 s27, 1835008, 0
    s_sub_u32 s36, s36, s27
    s_waitcnt vmcnt(4)
    s_barrier
    s_add_u32 m0, s37, 32768
    s_nop 0
    buffer_load_dwordx4 v3, s[8:11], s36 offen lds
    s_add_u32 m0, s37, 33792
    s_add_u32 s26, s36, 14336
    buffer_load_dwordx4 v3, s[8:11], s26 offen lds
    s_add_u32 m0, s37, 34816
    s_add_u32 s26, s36, 28672
    buffer_load_dwordx4 v3, s[8:11], s26 offen lds
    s_add_u32 m0, s37, 35840
    s_add_u32 s26, s36, 43008
    buffer_load_dwordx4 v3, s[8:11], s26 offen lds
    s_add_u32 s36, s36, 229376
    s_sub_u32 s38, s38, 1
    s_cmp_eq_u32 s38, 0
    s_cselect_b32 s27, 1835008, 0
    s_sub_u32 s36, s36, s27
    s_waitcnt vmcnt(4)
    s_barrier
    s_add_u32 m0, s37, 65536
    s_nop 0
    buffer_load_dwordx4 v3, s[8:11], s36 offen lds
    s_add_u32 m0, s37, 66560
    s_add_u32 s26, s36, 14336
    buffer_load_dwordx4 v3, s[8:11], s26 offen lds
    s_add_u32 m0, s37, 67584
    s_add_u32 s26, s36, 28672
    buffer_load_dwordx4 v3, s[8:11], s26 offen lds
    s_add_u32 m0, s37, 68608
    s_add_u32 s26, s36, 43008
    buffer_load_dwordx4 v3, s[8:11], s26 offen lds
    s_add_u32 s36, s36, 229376
    s_sub_u32 s38, s38, 1
    s_cmp_eq_u32 s38, 0
    s_cselect_b32 s27, 1835008, 0
    s_sub_u32 s36, s36, s27
    s_waitcnt vmcnt(4)
    s_barrier
    s_add_u32 m0, s37, 98304
    s_nop 0
    buffer_load_dwordx4 v3, s[8:11], s36 offen lds
    s_add_u32 m0, s37, 99328
    s_add_u32 s26, s36, 14336
    buffer_load_dwordx4 v3, s[8:11], s26 offen lds
    s_add_u32 m0, s37, 100352
    s_add_u32 s26, s36, 28672
    buffer_load_dwordx4 v3, s[8:11], s26 offen lds
    s_add_u32 m0, s37, 101376
    s_add_u32 s26, s36, 43008
    buffer_load_dwordx4 v3, s[8:11], s26 offen lds
    s_add_u32 s36, s36, 229376
    s_sub_u32 s38, s38, 1
    s_cmp_eq_u32 s38, 0
    s_cselect_b32 s27, 1835008, 0
    s_sub_u32 s36, s36, s27
    s_waitcnt vmcnt(4)
    s_barrier
    s_waitcnt vmcnt(0)
    s_barrier
    s_endpgm
mlp1_kernel_cons:
    s_and_b32 s23, s22, 2
    s_and_b32 s24, s22, 1
    s_lshl_b32 s24, s24, 1
    v_and_b32 v3, 31, v1
    v_lshrrev_b32 v4, 5, v1
    v_lshlrev_b32 v2, 4, v1
    s_lshl_b32 s27, s20, 2
    s_add_u32 s27, s27, s23
    s_waitcnt lgkmcnt(0)
    s_mov_b32 s18, 18874368
    s_mov_b32 s19, 0x00020000
    s_cmp_lg_u32 s25, 0
    s_cbranch_scc1 mlp1_kernel_pcs1
    s_cmp_lg_u32 s22, 0
    s_cbranch_scc1 mlp1_kernel_pcs1
    s_getpc_b64 s[80:81]
mlp1_kernel_pc2:
    s_add_u32 s80, s80, mlp2_kernel-mlp1_kernel_pc2
    s_addc_u32 s81, s81, 0
    v_lshlrev_b32 v127, 7, v1
    v_min_u32 v127, mlp2_kernel_end-mlp2_kernel-4, v127
    v_mov_b32 v125, s81
    v_add_co_u32 v124, vcc, s80, v127
    s_nop 1
    v_addc_co_u32 v125, vcc, 0, v125, vcc
    global_load_dword v126, v[124:125], off
mlp1_kernel_pcs1:
    v_lshrrev_b32 v4, 5, v1
    v_lshlrev_b32 v5, 4, v1
    s_mul_i32 s26, s23, 4096
    v_add_u32 v14, s26, v5
    v_bfe_u32 v7, v1, 2, 2
    v_lshl_add_u32 v8, v4, 2, v7
    v_mul_u32_u24 v8, 256, v8
    v_lshl_add_u32 v8, v7, 6, v8
    v_bfe_u32 v7, v1, 4, 1
    v_lshl_add_u32 v8, v7, 5, v8
    v_and_b32 v7, 3, v1
    v_lshl_add_u32 v8, v7, 3, v8
    v_add_u32 v8, 16384, v8
    s_lshl_b32 s26, s24, 6
    v_xor_b32 v15, s26, v8
    v_mov_b32 v16, v14
    v_mov_b32 v17, v15
    v_xor_b32 v18, 64, v15
    v_mov_b32 v19, v16
    v_mov_b32 v20, v17
    v_mov_b32 v21, v18
    v_lshlrev_b32 v5, 4, v4
    s_lshl_b32 s26, s24, 7
    s_add_u32 s26, s26, 131072
    v_add_u32 v5, s26, v5
    v_lshlrev_b32 v6, 4, v3
    s_lshl_b32 s26, s23, 9
    s_add_u32 s26, s26, 132096
    v_add_u32 v6, s26, v6
    s_barrier
    ds_read_b128 v[8:11], v6
    ds_read_b128 v[12:15], v6 offset:512
    ds_read_b128 v[60:63], v5 offset:512
    ds_read_b128 v[92:95], v5 offset:0
    ds_read_b128 v[64:67], v5 offset:544
    ds_read_b128 v[96:99], v5 offset:32
    ds_read_b128 v[68:71], v5 offset:576
    ds_read_b128 v[100:103], v5 offset:64
    ds_read_b128 v[72:75], v5 offset:608
    ds_read_b128 v[104:107], v5 offset:96
    ds_read_b128 v[76:79], v5 offset:640
    ds_read_b128 v[108:111], v5 offset:128
    ds_read_b128 v[80:83], v5 offset:672
    ds_read_b128 v[112:115], v5 offset:160
    ds_read_b128 v[84:87], v5 offset:704
    ds_read_b128 v[116:119], v5 offset:192
    ds_read_b128 v[88:91], v5 offset:736
    ds_read_b128 v[120:123], v5 offset:224
    s_waitcnt lgkmcnt(15)
    s_waitcnt lgkmcnt(8)
    v_mov_b32 v36, v8
    v_mov_b32 v37, v8
    v_mov_b32 v38, v9
    v_mov_b32 v39, v9
    v_mov_b32 v40, v12
    v_mov_b32 v41, v12
    v_mov_b32 v42, v13
    v_mov_b32 v43, v13
    v_pk_mul_f32 v[44:45], v[60:61], v[40:41]
    v_pk_mul_f32 v[46:47], v[62:63], v[40:41]
    v_pk_mul_f32 v[48:49], v[64:65], v[40:41]
    v_pk_mul_f32 v[50:51], v[66:67], v[40:41]
    v_pk_mul_f32 v[52:53], v[68:69], v[40:41]
    v_pk_mul_f32 v[54:55], v[70:71], v[40:41]
    v_pk_mul_f32 v[56:57], v[72:73], v[40:41]
    v_pk_mul_f32 v[58:59], v[74:75], v[40:41]
    v_pk_mul_f32 v[60:61], v[60:61], v[36:37]
    v_pk_mul_f32 v[62:63], v[62:63], v[36:37]
    v_pk_mul_f32 v[64:65], v[64:65], v[36:37]
    v_pk_mul_f32 v[66:67], v[66:67], v[36:37]
    v_pk_mul_f32 v[68:69], v[68:69], v[36:37]
    v_pk_mul_f32 v[70:71], v[70:71], v[36:37]
    v_pk_mul_f32 v[72:73], v[72:73], v[36:37]
    v_pk_mul_f32 v[74:75], v[74:75], v[36:37]
    v_pk_fma_f32 v[60:61], v[92:93], v[38:39], v[60:61]
    v_pk_fma_f32 v[62:63], v[94:95], v[38:39], v[62:63]
    v_pk_fma_f32 v[64:65], v[96:97], v[38:39], v[64:65]
    v_pk_fma_f32 v[66:67], v[98:99], v[38:39], v[66:67]
    v_pk_fma_f32 v[68:69], v[100:101], v[38:39], v[68:69]
    v_pk_fma_f32 v[70:71], v[102:103], v[38:39], v[70:71]
    v_pk_fma_f32 v[72:73], v[104:105], v[38:39], v[72:73]
    v_pk_fma_f32 v[74:75], v[106:107], v[38:39], v[74:75]
    v_pk_fma_f32 v[92:93], v[92:93], v[42:43], v[44:45]
    v_pk_fma_f32 v[94:95], v[94:95], v[42:43], v[46:47]
    v_pk_fma_f32 v[96:97], v[96:97], v[42:43], v[48:49]
    v_pk_fma_f32 v[98:99], v[98:99], v[42:43], v[50:51]
    v_pk_fma_f32 v[100:101], v[100:101], v[42:43], v[52:53]
    v_pk_fma_f32 v[102:103], v[102:103], v[42:43], v[54:55]
    v_pk_fma_f32 v[104:105], v[104:105], v[42:43], v[56:57]
    v_pk_fma_f32 v[106:107], v[106:107], v[42:43], v[58:59]
    s_waitcnt lgkmcnt(0)
    v_pk_mul_f32 v[44:45], v[76:77], v[40:41]
    v_pk_mul_f32 v[46:47], v[78:79], v[40:41]
    v_pk_mul_f32 v[48:49], v[80:81], v[40:41]
    v_pk_mul_f32 v[50:51], v[82:83], v[40:41]
    v_pk_mul_f32 v[52:53], v[84:85], v[40:41]
    v_pk_mul_f32 v[54:55], v[86:87], v[40:41]
    v_pk_mul_f32 v[56:57], v[88:89], v[40:41]
    v_pk_mul_f32 v[58:59], v[90:91], v[40:41]
    v_pk_mul_f32 v[76:77], v[76:77], v[36:37]
    v_pk_mul_f32 v[78:79], v[78:79], v[36:37]
    v_pk_mul_f32 v[80:81], v[80:81], v[36:37]
    v_pk_mul_f32 v[82:83], v[82:83], v[36:37]
    v_pk_mul_f32 v[84:85], v[84:85], v[36:37]
    v_pk_mul_f32 v[86:87], v[86:87], v[36:37]
    v_pk_mul_f32 v[88:89], v[88:89], v[36:37]
    v_pk_mul_f32 v[90:91], v[90:91], v[36:37]
    v_pk_fma_f32 v[76:77], v[108:109], v[38:39], v[76:77]
    v_pk_fma_f32 v[78:79], v[110:111], v[38:39], v[78:79]
    v_pk_fma_f32 v[80:81], v[112:113], v[38:39], v[80:81]
    v_pk_fma_f32 v[82:83], v[114:115], v[38:39], v[82:83]
    v_pk_fma_f32 v[84:85], v[116:117], v[38:39], v[84:85]
    v_pk_fma_f32 v[86:87], v[118:119], v[38:39], v[86:87]
    v_pk_fma_f32 v[88:89], v[120:121], v[38:39], v[88:89]
    v_pk_fma_f32 v[90:91], v[122:123], v[38:39], v[90:91]
    v_pk_fma_f32 v[108:109], v[108:109], v[42:43], v[44:45]
    v_pk_fma_f32 v[110:111], v[110:111], v[42:43], v[46:47]
    v_pk_fma_f32 v[112:113], v[112:113], v[42:43], v[48:49]
    v_pk_fma_f32 v[114:115], v[114:115], v[42:43], v[50:51]
    v_pk_fma_f32 v[116:117], v[116:117], v[42:43], v[52:53]
    v_pk_fma_f32 v[118:119], v[118:119], v[42:43], v[54:55]
    v_pk_fma_f32 v[120:121], v[120:121], v[42:43], v[56:57]
    v_pk_fma_f32 v[122:123], v[122:123], v[42:43], v[58:59]
    s_mov_b32 s34, 0
    s_mov_b32 s35, 0
    s_barrier
    ds_read_b128 v[28:31], v19 offset:0
    ds_read_b128 v[32:35], v19 offset:4096
    ds_read_b64_tr_b16 v[36:37], v20 offset:0
    ds_read_b64_tr_b16 v[38:39], v20 offset:2048
    ds_read_b64_tr_b16 v[40:41], v21 offset:0
    ds_read_b64_tr_b16 v[42:43], v21 offset:2048
    ds_read_b128 v[44:47], v19 offset:1024
    ds_read_b128 v[48:51], v19 offset:5120
    ds_read_b64_tr_b16 v[52:53], v20 offset:4096
    ds_read_b64_tr_b16 v[54:55], v20 offset:6144
    ds_read_b64_tr_b16 v[56:57], v21 offset:4096
    ds_read_b64_tr_b16 v[58:59], v21 offset:6144
mlp1_kernel_var0:
mlp1_kernel_loop0:
    s_waitcnt lgkmcnt(6)
    v_mfma_f32_32x32x16_bf16 v[60:75], v[36:39], v[28:31], v[60:75]
    v_mfma_f32_32x32x16_bf16 v[76:91], v[40:43], v[28:31], v[76:91]
    ds_read_b128 v[28:31], v19 offset:2048
    v_mfma_f32_32x32x16_bf16 v[92:107], v[36:39], v[32:35], v[92:107]
    ds_read_b64_tr_b16 v[36:37], v20 offset:8192
    ds_read_b64_tr_b16 v[38:39], v20 offset:10240
    v_mfma_f32_32x32x16_bf16 v[108:123], v[40:43], v[32:35], v[108:123]
    ds_read_b64_tr_b16 v[40:41], v21 offset:8192
    ds_read_b64_tr_b16 v[42:43], v21 offset:10240
    ds_read_b128 v[32:35], v19 offset:6144
    s_waitcnt lgkmcnt(6)
    v_mfma_f32_32x32x16_bf16 v[60:75], v[52:55], v[44:47], v[60:75]
    v_mfma_f32_32x32x16_bf16 v[76:91], v[56:59], v[44:47], v[76:91]
    ds_read_b128 v[44:47], v19 offset:3072
    v_mfma_f32_32x32x16_bf16 v[92:107], v[52:55], v[48:51], v[92:107]
    ds_read_b64_tr_b16 v[52:53], v20 offset:12288
    ds_read_b64_tr_b16 v[54:55], v20 offset:14336
    v_mfma_f32_32x32x16_bf16 v[108:123], v[56:59], v[48:51], v[108:123]
    ds_read_b64_tr_b16 v[56:57], v21 offset:12288
    ds_read_b64_tr_b16 v[58:59], v21 offset:14336
    ds_read_b128 v[48:51], v19 offset:7168
    s_add_u32 s34, s34, 32768
    s_cmp_eq_u32 s34, 131072
    s_cselect_b32 s34, 0, s34
    v_add_u32 v22, s34, v16
    v_add_u32 v23, s34, v17
    v_add_u32 v24, s34, v18
    s_barrier
    s_waitcnt lgkmcnt(6)
    v_mfma_f32_32x32x16_bf16 v[60:75], v[36:39], v[28:31], v[60:75]
    v_mfma_f32_32x32x16_bf16 v[76:91], v[40:43], v[28:31], v[76:91]
    ds_read_b128 v[28:31], v22 offset:0
    v_mfma_f32_32x32x16_bf16 v[92:107], v[36:39], v[32:35], v[92:107]
    ds_read_b64_tr_b16 v[36:37], v23 offset:0
    ds_read_b64_tr_b16 v[38:39], v23 offset:2048
    v_mfma_f32_32x32x16_bf16 v[108:123], v[40:43], v[32:35], v[108:123]
    ds_read_b64_tr_b16 v[40:41], v24 offset:0
    ds_read_b64_tr_b16 v[42:43], v24 offset:2048
    ds_read_b128 v[32:35], v22 offset:4096
    s_waitcnt lgkmcnt(6)
    v_mfma_f32_32x32x16_bf16 v[60:75], v[52:55], v[44:47], v[60:75]
    v_mfma_f32_32x32x16_bf16 v[76:91], v[56:59], v[44:47], v[76:91]
    ds_read_b128 v[44:47], v22 offset:1024
    v_mfma_f32_32x32x16_bf16 v[92:107], v[52:55], v[48:51], v[92:107]
    ds_read_b64_tr_b16 v[52:53], v23 offset:4096
    ds_read_b64_tr_b16 v[54:55], v23 offset:6144
    v_mfma_f32_32x32x16_bf16 v[108:123], v[56:59], v[48:51], v[108:123]
    ds_read_b64_tr_b16 v[56:57], v24 offset:4096
    ds_read_b64_tr_b16 v[58:59], v24 offset:6144
    ds_read_b128 v[48:51], v22 offset:5120
    v_mov_b32 v19, v22
    v_mov_b32 v20, v23
    v_mov_b32 v21, v24
    s_add_u32 s35, s35, 1
    s_cmp_lt_u32 s35, 7
    s_cbranch_scc1 mlp1_kernel_loop0
    s_waitcnt lgkmcnt(6)
    v_mfma_f32_32x32x16_bf16 v[60:75], v[36:39], v[28:31], v[60:75]
    v_mfma_f32_32x32x16_bf16 v[76:91], v[40:43], v[28:31], v[76:91]
    ds_read_b128 v[28:31], v19 offset:2048
    v_mfma_f32_32x32x16_bf16 v[92:107], v[36:39], v[32:35], v[92:107]
    ds_read_b64_tr_b16 v[36:37], v20 offset:8192
    ds_read_b64_tr_b16 v[38:39], v20 offset:10240
    v_mfma_f32_32x32x16_bf16 v[108:123], v[40:43], v[32:35], v[108:123]
    ds_read_b64_tr_b16 v[40:41], v21 offset:8192
    ds_read_b64_tr_b16 v[42:43], v21 offset:10240
    ds_read_b128 v[32:35], v19 offset:6144
    s_waitcnt lgkmcnt(6)
    v_mfma_f32_32x32x16_bf16 v[60:75], v[52:55], v[44:47], v[60:75]
    v_mfma_f32_32x32x16_bf16 v[76:91], v[56:59], v[44:47], v[76:91]
    ds_read_b128 v[44:47], v19 offset:3072
    v_mfma_f32_32x32x16_bf16 v[92:107], v[52:55], v[48:51], v[92:107]
    ds_read_b64_tr_b16 v[52:53], v20 offset:12288
    ds_read_b64_tr_b16 v[54:55], v20 offset:14336
    v_mfma_f32_32x32x16_bf16 v[108:123], v[56:59], v[48:51], v[108:123]
    ds_read_b64_tr_b16 v[56:57], v21 offset:12288
    ds_read_b64_tr_b16 v[58:59], v21 offset:14336
    ds_read_b128 v[48:51], v19 offset:7168
    s_waitcnt lgkmcnt(6)
    v_mfma_f32_32x32x16_bf16 v[60:75], v[36:39], v[28:31], v[60:75]
    v_mfma_f32_32x32x16_bf16 v[76:91], v[40:43], v[28:31], v[76:91]
    v_mfma_f32_32x32x16_bf16 v[92:107], v[36:39], v[32:35], v[92:107]
    v_mfma_f32_32x32x16_bf16 v[108:123], v[40:43], v[32:35], v[108:123]
    s_waitcnt lgkmcnt(0)
    v_mfma_f32_32x32x16_bf16 v[60:75], v[52:55], v[44:47], v[60:75]
    v_mfma_f32_32x32x16_bf16 v[76:91], v[56:59], v[44:47], v[76:91]
    v_mfma_f32_32x32x16_bf16 v[92:107], v[52:55], v[48:51], v[92:107]
    v_mfma_f32_32x32x16_bf16 v[108:123], v[56:59], v[48:51], v[108:123]
mlp1_kernel_epi:
    s_mul_i32 s30, s27, 114688
    s_lshl_b32 s26, s21, 13
    s_add_u32 s30, s30, s26
    s_lshl_b32 s26, s24, 11
    s_add_u32 s30, s30, s26
    s_add_u32 s30, s30, 10485760
    v_mov_b32 v16, v8
    v_mov_b32 v17, v8
    v_mov_b32 v18, v10
    v_mov_b32 v19, v10
    v_mov_b32 v20, v11
    v_mov_b32 v21, v11
    v_mov_b32 v22, v12
    v_mov_b32 v23, v12
    v_mov_b32 v24, v14
    v_mov_b32 v25, v14
    v_mov_b32 v26, v15
    v_mov_b32 v27, v15
    v_pk_mul_f32 v[28:29], v[60:61], v[60:61]
    v_pk_mul_f32 v[30:31], v[62:63], v[62:63]
    v_pk_mul_f32 v[32:33], v[64:65], v[64:65]
    v_pk_mul_f32 v[34:35], v[66:67], v[66:67]
    v_pk_mul_f32 v[36:37], v[68:69], v[68:69]
    v_pk_mul_f32 v[38:39], v[70:71], v[70:71]
    v_pk_mul_f32 v[40:41], v[72:73], v[72:73]
    v_pk_mul_f32 v[42:43], v[74:75], v[74:75]
    v_pk_fma_f32 v[28:29], v[28:29], v[20:21], v[18:19]
    v_pk_fma_f32 v[30:31], v[30:31], v[20:21], v[18:19]
    v_pk_fma_f32 v[32:33], v[32:33], v[20:21], v[18:19]
    v_pk_fma_f32 v[34:35], v[34:35], v[20:21], v[18:19]
    v_pk_fma_f32 v[36:37], v[36:37], v[20:21], v[18:19]
    v_pk_fma_f32 v[38:39], v[38:39], v[20:21], v[18:19]
    v_pk_fma_f32 v[40:41], v[40:41], v[20:21], v[18:19]
    v_pk_fma_f32 v[42:43], v[42:43], v[20:21], v[18:19]
    v_pk_mul_f32 v[28:29], v[28:29], v[60:61]
    v_pk_mul_f32 v[30:31], v[30:31], v[62:63]
    v_pk_mul_f32 v[32:33], v[32:33], v[64:65]
    v_pk_mul_f32 v[34:35], v[34:35], v[66:67]
    v_pk_mul_f32 v[36:37], v[36:37], v[68:69]
    v_pk_mul_f32 v[38:39], v[38:39], v[70:71]
    v_pk_mul_f32 v[40:41], v[40:41], v[72:73]
    v_pk_mul_f32 v[42:43], v[42:43], v[74:75]
    v_exp_f32 v28, v28
    v_exp_f32 v29, v29
    v_exp_f32 v30, v30
    v_exp_f32 v31, v31
    v_exp_f32 v32, v32
    v_exp_f32 v33, v33
    v_exp_f32 v34, v34
    v_exp_f32 v35, v35
    v_exp_f32 v36, v36
    v_exp_f32 v37, v37
    v_exp_f32 v38, v38
    v_exp_f32 v39, v39
    v_exp_f32 v40, v40
    v_exp_f32 v41, v41
    v_exp_f32 v42, v42
    v_exp_f32 v43, v43
    v_pk_fma_f32 v[28:29], v[28:29], v[16:17], v[16:17]
    v_pk_fma_f32 v[30:31], v[30:31], v[16:17], v[16:17]
    v_pk_fma_f32 v[32:33], v[32:33], v[16:17], v[16:17]
    v_pk_fma_f32 v[34:35], v[34:35], v[16:17], v[16:17]
    v_pk_fma_f32 v[36:37], v[36:37], v[16:17], v[16:17]
    v_pk_fma_f32 v[38:39], v[38:39], v[16:17], v[16:17]
    v_pk_fma_f32 v[40:41], v[40:41], v[16:17], v[16:17]
    v_pk_fma_f32 v[42:43], v[42:43], v[16:17], v[16:17]
    v_rcp_f32 v28, v28
    v_rcp_f32 v29, v29
    v_rcp_f32 v30, v30
    v_rcp_f32 v31, v31
    v_rcp_f32 v32, v32
    v_rcp_f32 v33, v33
    v_rcp_f32 v34, v34
    v_rcp_f32 v35, v35
    v_rcp_f32 v36, v36
    v_rcp_f32 v37, v37
    v_rcp_f32 v38, v38
    v_rcp_f32 v39, v39
    v_rcp_f32 v40, v40
    v_rcp_f32 v41, v41
    v_rcp_f32 v42, v42
    v_rcp_f32 v43, v43
    v_pk_mul_f32 v[60:61], v[60:61], v[28:29]
    v_pk_mul_f32 v[62:63], v[62:63], v[30:31]
    v_pk_mul_f32 v[64:65], v[64:65], v[32:33]
    v_pk_mul_f32 v[66:67], v[66:67], v[34:35]
    v_pk_mul_f32 v[68:69], v[68:69], v[36:37]
    v_pk_mul_f32 v[70:71], v[70:71], v[38:39]
    v_pk_mul_f32 v[72:73], v[72:73], v[40:41]
    v_pk_mul_f32 v[74:75], v[74:75], v[42:43]
    v_cvt_pk_bf16_f32 v60, v60, v61
    v_cvt_pk_bf16_f32 v61, v62, v63
    v_cvt_pk_bf16_f32 v62, v64, v65
    v_cvt_pk_bf16_f32 v63, v66, v67
    v_cvt_pk_bf16_f32 v64, v68, v69
    v_cvt_pk_bf16_f32 v65, v70, v71
    v_cvt_pk_bf16_f32 v66, v72, v73
    v_cvt_pk_bf16_f32 v67, v74, v75
    s_add_u32 s26, s30, 0
    buffer_store_dwordx4 v[60:63], v2, s[16:19], s26 offen sc1
    buffer_store_dwordx4 v[64:67], v2, s[16:19], s26 offen offset:1024 sc1
    v_pk_mul_f32 v[44:45], v[92:93], v[92:93]
    v_pk_mul_f32 v[46:47], v[94:95], v[94:95]
    v_pk_mul_f32 v[48:49], v[96:97], v[96:97]
    v_pk_mul_f32 v[50:51], v[98:99], v[98:99]
    v_pk_mul_f32 v[52:53], v[100:101], v[100:101]
    v_pk_mul_f32 v[54:55], v[102:103], v[102:103]
    v_pk_mul_f32 v[56:57], v[104:105], v[104:105]
    v_pk_mul_f32 v[58:59], v[106:107], v[106:107]
    v_pk_fma_f32 v[44:45], v[44:45], v[26:27], v[24:25]
    v_pk_fma_f32 v[46:47], v[46:47], v[26:27], v[24:25]
    v_pk_fma_f32 v[48:49], v[48:49], v[26:27], v[24:25]
    v_pk_fma_f32 v[50:51], v[50:51], v[26:27], v[24:25]
    v_pk_fma_f32 v[52:53], v[52:53], v[26:27], v[24:25]
    v_pk_fma_f32 v[54:55], v[54:55], v[26:27], v[24:25]
    v_pk_fma_f32 v[56:57], v[56:57], v[26:27], v[24:25]
    v_pk_fma_f32 v[58:59], v[58:59], v[26:27], v[24:25]
    v_pk_mul_f32 v[44:45], v[44:45], v[92:93]
    v_pk_mul_f32 v[46:47], v[46:47], v[94:95]
    v_pk_mul_f32 v[48:49], v[48:49], v[96:97]
    v_pk_mul_f32 v[50:51], v[50:51], v[98:99]
    v_pk_mul_f32 v[52:53], v[52:53], v[100:101]
    v_pk_mul_f32 v[54:55], v[54:55], v[102:103]
    v_pk_mul_f32 v[56:57], v[56:57], v[104:105]
    v_pk_mul_f32 v[58:59], v[58:59], v[106:107]
    v_exp_f32 v44, v44
    v_exp_f32 v45, v45
    v_exp_f32 v46, v46
    v_exp_f32 v47, v47
    v_exp_f32 v48, v48
    v_exp_f32 v49, v49
    v_exp_f32 v50, v50
    v_exp_f32 v51, v51
    v_exp_f32 v52, v52
    v_exp_f32 v53, v53
    v_exp_f32 v54, v54
    v_exp_f32 v55, v55
    v_exp_f32 v56, v56
    v_exp_f32 v57, v57
    v_exp_f32 v58, v58
    v_exp_f32 v59, v59
    v_pk_fma_f32 v[44:45], v[44:45], v[22:23], v[22:23]
    v_pk_fma_f32 v[46:47], v[46:47], v[22:23], v[22:23]
    v_pk_fma_f32 v[48:49], v[48:49], v[22:23], v[22:23]
    v_pk_fma_f32 v[50:51], v[50:51], v[22:23], v[22:23]
    v_pk_fma_f32 v[52:53], v[52:53], v[22:23], v[22:23]
    v_pk_fma_f32 v[54:55], v[54:55], v[22:23], v[22:23]
    v_pk_fma_f32 v[56:57], v[56:57], v[22:23], v[22:23]
    v_pk_fma_f32 v[58:59], v[58:59], v[22:23], v[22:23]
    v_rcp_f32 v44, v44
    v_rcp_f32 v45, v45
    v_rcp_f32 v46, v46
    v_rcp_f32 v47, v47
    v_rcp_f32 v48, v48
    v_rcp_f32 v49, v49
    v_rcp_f32 v50, v50
    v_rcp_f32 v51, v51
    v_rcp_f32 v52, v52
    v_rcp_f32 v53, v53
    v_rcp_f32 v54, v54
    v_rcp_f32 v55, v55
    v_rcp_f32 v56, v56
    v_rcp_f32 v57, v57
    v_rcp_f32 v58, v58
    v_rcp_f32 v59, v59
    v_pk_mul_f32 v[92:93], v[92:93], v[44:45]
    v_pk_mul_f32 v[94:95], v[94:95], v[46:47]
    v_pk_mul_f32 v[96:97], v[96:97], v[48:49]
    v_pk_mul_f32 v[98:99], v[98:99], v[50:51]
    v_pk_mul_f32 v[100:101], v[100:101], v[52:53]
    v_pk_mul_f32 v[102:103], v[102:103], v[54:55]
    v_pk_mul_f32 v[104:105], v[104:105], v[56:57]
    v_pk_mul_f32 v[106:107], v[106:107], v[58:59]
    v_cvt_pk_bf16_f32 v92, v92, v93
    v_cvt_pk_bf16_f32 v93, v94, v95
    v_cvt_pk_bf16_f32 v94, v96, v97
    v_cvt_pk_bf16_f32 v95, v98, v99
    v_cvt_pk_bf16_f32 v96, v100, v101
    v_cvt_pk_bf16_f32 v97, v102, v103
    v_cvt_pk_bf16_f32 v98, v104, v105
    v_cvt_pk_bf16_f32 v99, v106, v107
    s_add_u32 s26, s30, 114688
    buffer_store_dwordx4 v[92:95], v2, s[16:19], s26 offen sc1
    buffer_store_dwordx4 v[96:99], v2, s[16:19], s26 offen offset:1024 sc1
    v_pk_mul_f32 v[28:29], v[76:77], v[76:77]
    v_pk_mul_f32 v[30:31], v[78:79], v[78:79]
    v_pk_mul_f32 v[32:33], v[80:81], v[80:81]
    v_pk_mul_f32 v[34:35], v[82:83], v[82:83]
    v_pk_mul_f32 v[36:37], v[84:85], v[84:85]
    v_pk_mul_f32 v[38:39], v[86:87], v[86:87]
    v_pk_mul_f32 v[40:41], v[88:89], v[88:89]
    v_pk_mul_f32 v[42:43], v[90:91], v[90:91]
    v_pk_fma_f32 v[28:29], v[28:29], v[20:21], v[18:19]
    v_pk_fma_f32 v[30:31], v[30:31], v[20:21], v[18:19]
    v_pk_fma_f32 v[32:33], v[32:33], v[20:21], v[18:19]
    v_pk_fma_f32 v[34:35], v[34:35], v[20:21], v[18:19]
    v_pk_fma_f32 v[36:37], v[36:37], v[20:21], v[18:19]
    v_pk_fma_f32 v[38:39], v[38:39], v[20:21], v[18:19]
    v_pk_fma_f32 v[40:41], v[40:41], v[20:21], v[18:19]
    v_pk_fma_f32 v[42:43], v[42:43], v[20:21], v[18:19]
    v_pk_mul_f32 v[28:29], v[28:29], v[76:77]
    v_pk_mul_f32 v[30:31], v[30:31], v[78:79]
    v_pk_mul_f32 v[32:33], v[32:33], v[80:81]
    v_pk_mul_f32 v[34:35], v[34:35], v[82:83]
    v_pk_mul_f32 v[36:37], v[36:37], v[84:85]
    v_pk_mul_f32 v[38:39], v[38:39], v[86:87]
    v_pk_mul_f32 v[40:41], v[40:41], v[88:89]
    v_pk_mul_f32 v[42:43], v[42:43], v[90:91]
    v_exp_f32 v28, v28
    v_exp_f32 v29, v29
    v_exp_f32 v30, v30
    v_exp_f32 v31, v31
    v_exp_f32 v32, v32
    v_exp_f32 v33, v33
    v_exp_f32 v34, v34
    v_exp_f32 v35, v35
    v_exp_f32 v36, v36
    v_exp_f32 v37, v37
    v_exp_f32 v38, v38
    v_exp_f32 v39, v39
    v_exp_f32 v40, v40
    v_exp_f32 v41, v41
    v_exp_f32 v42, v42
    v_exp_f32 v43, v43
    v_pk_fma_f32 v[28:29], v[28:29], v[16:17], v[16:17]
    v_pk_fma_f32 v[30:31], v[30:31], v[16:17], v[16:17]
    v_pk_fma_f32 v[32:33], v[32:33], v[16:17], v[16:17]
    v_pk_fma_f32 v[34:35], v[34:35], v[16:17], v[16:17]
    v_pk_fma_f32 v[36:37], v[36:37], v[16:17], v[16:17]
    v_pk_fma_f32 v[38:39], v[38:39], v[16:17], v[16:17]
    v_pk_fma_f32 v[40:41], v[40:41], v[16:17], v[16:17]
    v_pk_fma_f32 v[42:43], v[42:43], v[16:17], v[16:17]
    v_rcp_f32 v28, v28
    v_rcp_f32 v29, v29
    v_rcp_f32 v30, v30
    v_rcp_f32 v31, v31
    v_rcp_f32 v32, v32
    v_rcp_f32 v33, v33
    v_rcp_f32 v34, v34
    v_rcp_f32 v35, v35
    v_rcp_f32 v36, v36
    v_rcp_f32 v37, v37
    v_rcp_f32 v38, v38
    v_rcp_f32 v39, v39
    v_rcp_f32 v40, v40
    v_rcp_f32 v41, v41
    v_rcp_f32 v42, v42
    v_rcp_f32 v43, v43
    v_pk_mul_f32 v[76:77], v[76:77], v[28:29]
    v_pk_mul_f32 v[78:79], v[78:79], v[30:31]
    v_pk_mul_f32 v[80:81], v[80:81], v[32:33]
    v_pk_mul_f32 v[82:83], v[82:83], v[34:35]
    v_pk_mul_f32 v[84:85], v[84:85], v[36:37]
    v_pk_mul_f32 v[86:87], v[86:87], v[38:39]
    v_pk_mul_f32 v[88:89], v[88:89], v[40:41]
    v_pk_mul_f32 v[90:91], v[90:91], v[42:43]
    v_cvt_pk_bf16_f32 v76, v76, v77
    v_cvt_pk_bf16_f32 v77, v78, v79
    v_cvt_pk_bf16_f32 v78, v80, v81
    v_cvt_pk_bf16_f32 v79, v82, v83
    v_cvt_pk_bf16_f32 v80, v84, v85
    v_cvt_pk_bf16_f32 v81, v86, v87
    v_cvt_pk_bf16_f32 v82, v88, v89
    v_cvt_pk_bf16_f32 v83, v90, v91
    s_add_u32 s26, s30, 2048
    buffer_store_dwordx4 v[76:79], v2, s[16:19], s26 offen sc1
    buffer_store_dwordx4 v[80:83], v2, s[16:19], s26 offen offset:1024 sc1
    v_pk_mul_f32 v[44:45], v[108:109], v[108:109]
    v_pk_mul_f32 v[46:47], v[110:111], v[110:111]
    v_pk_mul_f32 v[48:49], v[112:113], v[112:113]
    v_pk_mul_f32 v[50:51], v[114:115], v[114:115]
    v_pk_mul_f32 v[52:53], v[116:117], v[116:117]
    v_pk_mul_f32 v[54:55], v[118:119], v[118:119]
    v_pk_mul_f32 v[56:57], v[120:121], v[120:121]
    v_pk_mul_f32 v[58:59], v[122:123], v[122:123]
    v_pk_fma_f32 v[44:45], v[44:45], v[26:27], v[24:25]
    v_pk_fma_f32 v[46:47], v[46:47], v[26:27], v[24:25]
    v_pk_fma_f32 v[48:49], v[48:49], v[26:27], v[24:25]
    v_pk_fma_f32 v[50:51], v[50:51], v[26:27], v[24:25]
    v_pk_fma_f32 v[52:53], v[52:53], v[26:27], v[24:25]
    v_pk_fma_f32 v[54:55], v[54:55], v[26:27], v[24:25]
    v_pk_fma_f32 v[56:57], v[56:57], v[26:27], v[24:25]
    v_pk_fma_f32 v[58:59], v[58:59], v[26:27], v[24:25]
    v_pk_mul_f32 v[44:45], v[44:45], v[108:109]
    v_pk_mul_f32 v[46:47], v[46:47], v[110:111]
    v_pk_mul_f32 v[48:49], v[48:49], v[112:113]
    v_pk_mul_f32 v[50:51], v[50:51], v[114:115]
    v_pk_mul_f32 v[52:53], v[52:53], v[116:117]
    v_pk_mul_f32 v[54:55], v[54:55], v[118:119]
    v_pk_mul_f32 v[56:57], v[56:57], v[120:121]
    v_pk_mul_f32 v[58:59], v[58:59], v[122:123]
    v_exp_f32 v44, v44
    v_exp_f32 v45, v45
    v_exp_f32 v46, v46
    v_exp_f32 v47, v47
    v_exp_f32 v48, v48
    v_exp_f32 v49, v49
    v_exp_f32 v50, v50
    v_exp_f32 v51, v51
    v_exp_f32 v52, v52
    v_exp_f32 v53, v53
    v_exp_f32 v54, v54
    v_exp_f32 v55, v55
    v_exp_f32 v56, v56
    v_exp_f32 v57, v57
    v_exp_f32 v58, v58
    v_exp_f32 v59, v59
    v_pk_fma_f32 v[44:45], v[44:45], v[22:23], v[22:23]
    v_pk_fma_f32 v[46:47], v[46:47], v[22:23], v[22:23]
    v_pk_fma_f32 v[48:49], v[48:49], v[22:23], v[22:23]
    v_pk_fma_f32 v[50:51], v[50:51], v[22:23], v[22:23]
    v_pk_fma_f32 v[52:53], v[52:53], v[22:23], v[22:23]
    v_pk_fma_f32 v[54:55], v[54:55], v[22:23], v[22:23]
    v_pk_fma_f32 v[56:57], v[56:57], v[22:23], v[22:23]
    v_pk_fma_f32 v[58:59], v[58:59], v[22:23], v[22:23]
    v_rcp_f32 v44, v44
    v_rcp_f32 v45, v45
    v_rcp_f32 v46, v46
    v_rcp_f32 v47, v47
    v_rcp_f32 v48, v48
    v_rcp_f32 v49, v49
    v_rcp_f32 v50, v50
    v_rcp_f32 v51, v51
    v_rcp_f32 v52, v52
    v_rcp_f32 v53, v53
    v_rcp_f32 v54, v54
    v_rcp_f32 v55, v55
    v_rcp_f32 v56, v56
    v_rcp_f32 v57, v57
    v_rcp_f32 v58, v58
    v_rcp_f32 v59, v59
    v_pk_mul_f32 v[108:109], v[108:109], v[44:45]
    v_pk_mul_f32 v[110:111], v[110:111], v[46:47]
    v_pk_mul_f32 v[112:113], v[112:113], v[48:49]
    v_pk_mul_f32 v[114:115], v[114:115], v[50:51]
    v_pk_mul_f32 v[116:117], v[116:117], v[52:53]
    v_pk_mul_f32 v[118:119], v[118:119], v[54:55]
    v_pk_mul_f32 v[120:121], v[120:121], v[56:57]
    v_pk_mul_f32 v[122:123], v[122:123], v[58:59]
    v_cvt_pk_bf16_f32 v108, v108, v109
    v_cvt_pk_bf16_f32 v109, v110, v111
    v_cvt_pk_bf16_f32 v110, v112, v113
    v_cvt_pk_bf16_f32 v111, v114, v115
    v_cvt_pk_bf16_f32 v112, v116, v117
    v_cvt_pk_bf16_f32 v113, v118, v119
    v_cvt_pk_bf16_f32 v114, v120, v121
    v_cvt_pk_bf16_f32 v115, v122, v123
    s_add_u32 s26, s30, 116736
    buffer_store_dwordx4 v[108:111], v2, s[16:19], s26 offen sc1
    buffer_store_dwordx4 v[112:115], v2, s[16:19], s26 offen offset:1024 sc1
mlp1_kernel_done:
    s_endpgm
mlp1_kernel_end:
.globl mlp2_kernel
.p2align 8
.type mlp2_kernel,@function
mlp2_kernel:
    s_cmp_ge_u32 s2, 256
    s_cbranch_scc1 mlp2_kernel_done
    s_load_dwordx2 s[16:17], s[0:1], 80
    s_load_dwordx2 s[4:5], s[0:1], 48
    s_load_dwordx4 s[40:43], s[0:1], 56
    s_and_b32 s24, s2, 7
    s_lshr_b32 s25, s2, 3
    s_lshl_b32 s20, s24, 2
    s_and_b32 s26, s25, 3
    s_add_u32 s20, s20, s26
    s_lshr_b32 s21, s25, 2
    v_lshrrev_b32 v2, 6, v0
    v_and_b32 v1, 63, v0
    v_readfirstlane_b32 s22, v2
    s_nop 3
    s_add_u32 s36, s22, 4
    s_sub_u32 s37, s22, 8
    s_cmp_lt_u32 s22, 8
    s_cselect_b32 s36, s36, s37
    s_cmp_ge_u32 s22, 12
    s_cselect_b32 s22, s22, s36
    s_mul_i32 s29, s21, 28
    s_lshr_b32 s29, s29, 3
    s_mov_b32 s29, 0
    s_mul_i32 s30, s20, 229376
    s_add_u32 s30, s30, 10485760
    s_lshl_b32 s32, s21, 7
    s_cmp_lt_u32 s22, 4
    s_cbranch_scc1 mlp2_kernel_cons
    s_cmp_ge_u32 s22, 8
    s_cbranch_scc1 mlp2_kernel_wprod
    s_sub_u32 s23, s22, 4
    v_lshlrev_b32 v2, 4, v1
    s_lshr_b32 s26, s23, 1
    s_mul_i32 s34, s26, 114688
    s_and_b32 s26, s23, 1
    s_mul_i32 s26, s26, 2048
    s_add_u32 s34, s34, s26
    s_add_u32 s34, s34, s30
    s_mul_i32 s35, s23, 2048
    s_mul_i32 s38, s29, 4096
    s_add_u32 s34, s34, s38
    s_sub_u32 s38, 28, s29
    s_waitcnt lgkmcnt(0)
    s_mov_b32 s18, 18874368
    s_mov_b32 s19, 0x00020000
    s_add_u32 m0, s35, 0
    s_nop 0
    buffer_load_dwordx4 v2, s[16:19], s34 offen lds
    s_add_u32 m0, s35, 1024
    s_add_u32 s26, s34, 1024
    buffer_load_dwordx4 v2, s[16:19], s26 offen lds
    s_add_u32 s34, s34, 4096
    s_sub_u32 s38, s38, 1
    s_cmp_eq_u32 s38, 0
    s_cselect_b32 s26, 114688, 0
    s_sub_u32 s34, s34, s26
    s_add_u32 m0, s35, 16384
    s_nop 0
    buffer_load_dwordx4 v2, s[16:19], s34 offen lds
    s_add_u32 m0, s35, 17408
    s_add_u32 s26, s34, 1024
    buffer_load_dwordx4 v2, s[16:19], s26 offen lds
    s_add_u32 s34, s34, 4096
    s_sub_u32 s38, s38, 1
    s_cmp_eq_u32 s38, 0
    s_cselect_b32 s26, 114688, 0
    s_sub_u32 s34, s34, s26
    s_add_u32 m0, s35, 32768
    s_nop 0
    buffer_load_dwordx4 v2, s[16:19], s34 offen lds
    s_add_u32 m0, s35, 33792
    s_add_u32 s26, s34, 1024
    buffer_load_dwordx4 v2, s[16:19], s26 offen lds
    s_add_u32 s34, s34, 4096
    s_sub_u32 s38, s38, 1
    s_cmp_eq_u32 s38, 0
    s_cselect_b32 s26, 114688, 0
    s_sub_u32 s34, s34, s26
    s_add_u32 m0, s35, 49152
    s_nop 0
    buffer_load_dwordx4 v2, s[16:19], s34 offen lds
    s_add_u32 m0, s35, 50176
    s_add_u32 s26, s34, 1024
    buffer_load_dwordx4 v2, s[16:19], s26 offen lds
    s_add_u32 s34, s34, 4096
    s_sub_u32 s38, s38, 1
    s_cmp_eq_u32 s38, 0
    s_cselect_b32 s26, 114688, 0
    s_sub_u32 s34, s34, s26
    s_waitcnt vmcnt(6)
    s_barrier
    s_add_u32 m0, s35, 65536
    s_nop 0
    buffer_load_dwordx4 v2, s[16:19], s34 offen lds
    s_add_u32 m0, s35, 66560
    s_add_u32 s26, s34, 1024
    buffer_load_dwordx4 v2, s[16:19], s26 offen lds
    s_add_u32 s34, s34, 4096
    s_sub_u32 s38, s38, 1
    s_cmp_eq_u32 s38, 0
    s_cselect_b32 s26, 114688, 0
    s_sub_u32 s34, s34, s26
    s_waitcnt vmcnt(6)
    s_barrier
    s_add_u32 m0, s35, 81920
    s_nop 0
    buffer_load_dwordx4 v2, s[16:19], s34 offen lds
    s_add_u32 m0, s35, 82944
    s_add_u32 s26, s34, 1024
    buffer_load_dwordx4 v2, s[16:19], s26 offen lds
    s_add_u32 s34, s34, 4096
    s_sub_u32 s38, s38, 1
    s_cmp_eq_u32 s38, 0
    s_cselect_b32 s26, 114688, 0
    s_sub_u32 s34, s34, s26
    s_waitcnt vmcnt(6)
    s_barrier
    s_add_u32 m0, s35, 98304
    s_nop 0
    buffer_load_dwordx4 v2, s[16:19], s34 offen lds
    s_add_u32 m0, s35, 99328
    s_add_u32 s26, s34, 1024
    buffer_load_dwordx4 v2, s[16:19], s26 offen lds
    s_add_u32 s34, s34, 4096
    s_sub_u32 s38, s38, 1
    s_cmp_eq_u32 s38, 0
    s_cselect_b32 s26, 114688, 0
    s_sub_u32 s34, s34, s26
    s_waitcnt vmcnt(6)
    s_barrier
    s_add_u32 m0, s35, 114688
    s_nop 0
    buffer_load_dwordx4 v2, s[16:19], s34 offen lds
    s_add_u32 m0, s35, 115712
    s_add_u32 s26, s34, 1024
    buffer_load_dwordx4 v2, s[16:19], s26 offen lds
    s_add_u32 s34, s34, 4096
    s_sub_u32 s38, s38, 1
    s_cmp_eq_u32 s38, 0
    s_cselect_b32 s26, 114688, 0
    s_sub_u32 s34, s34, s26
    s_waitcnt vmcnt(6)
    s_barrier
    s_add_u32 m0, s35, 0
    s_nop 0
    buffer_load_dwordx4 v2, s[16:19], s34 offen lds
    s_add_u32 m0, s35, 1024
    s_add_u32 s26, s34, 1024
    buffer_load_dwordx4 v2, s[16:19], s26 offen lds
    s_add_u32 s34, s34, 4096
    s_sub_u32 s38, s38, 1
    s_cmp_eq_u32 s38, 0
    s_cselect_b32 s26, 114688, 0
    s_sub_u32 s34, s34, s26
    s_waitcnt vmcnt(6)
    s_barrier
    s_add_u32 m0, s35, 16384
    s_nop 0
    buffer_load_dwordx4 v2, s[16:19], s34 offen lds
    s_add_u32 m0, s35, 17408
    s_add_u32 s26, s34, 1024
    buffer_load_dwordx4 v2, s[16:19], s26 offen lds
    s_add_u32 s34, s34, 4096
    s_sub_u32 s38, s38, 1
    s_cmp_eq_u32 s38, 0
    s_cselect_b32 s26, 114688, 0
    s_sub_u32 s34, s34, s26
    s_waitcnt vmcnt(6)
    s_barrier
    s_add_u32 m0, s35, 32768
    s_nop 0
    buffer_load_dwordx4 v2, s[16:19], s34 offen lds
    s_add_u32 m0, s35, 33792
    s_add_u32 s26, s34, 1024
    buffer_load_dwordx4 v2, s[16:19], s26 offen lds
    s_add_u32 s34, s34, 4096
    s_sub_u32 s38, s38, 1
    s_cmp_eq_u32 s38, 0
    s_cselect_b32 s26, 114688, 0
    s_sub_u32 s34, s34, s26
    s_waitcnt vmcnt(6)
    s_barrier
    s_add_u32 m0, s35, 49152
    s_nop 0
    buffer_load_dwordx4 v2, s[16:19], s34 offen lds
    s_add_u32 m0, s35, 50176
    s_add_u32 s26, s34, 1024
    buffer_load_dwordx4 v2, s[16:19], s26 offen lds
    s_add_u32 s34, s34, 4096
    s_sub_u32 s38, s38, 1
    s_cmp_eq_u32 s38, 0
    s_cselect_b32 s26, 114688, 0
    s_sub_u32 s34, s34, s26
    s_waitcnt vmcnt(6)
    s_barrier
    s_add_u32 m0, s35, 65536
    s_nop 0
    buffer_load_dwordx4 v2, s[16:19], s34 offen lds
    s_add_u32 m0, s35, 66560
    s_add_u32 s26, s34, 1024
    buffer_load_dwordx4 v2, s[16:19], s26 offen lds
    s_add_u32 s34, s34, 4096
    s_sub_u32 s38, s38, 1
    s_cmp_eq_u32 s38, 0
    s_cselect_b32 s26, 114688, 0
    s_sub_u32 s34, s34, s26
    s_waitcnt vmcnt(6)
    s_barrier
    s_add_u32 m0, s35, 81920
    s_nop 0
    buffer_load_dwordx4 v2, s[16:19], s34 offen lds
    s_add_u32 m0, s35, 82944
    s_add_u32 s26, s34, 1024
    buffer_load_dwordx4 v2, s[16:19], s26 offen lds
    s_add_u32 s34, s34, 4096
    s_sub_u32 s38, s38, 1
    s_cmp_eq_u32 s38, 0
    s_cselect_b32 s26, 114688, 0
    s_sub_u32 s34, s34, s26
    s_waitcnt vmcnt(6)
    s_barrier
    s_add_u32 m0, s35, 98304
    s_nop 0
    buffer_load_dwordx4 v2, s[16:19], s34 offen lds
    s_add_u32 m0, s35, 99328
    s_add_u32 s26, s34, 1024
    buffer_load_dwordx4 v2, s[16:19], s26 offen lds
    s_add_u32 s34, s34, 4096
    s_sub_u32 s38, s38, 1
    s_cmp_eq_u32 s38, 0
    s_cselect_b32 s26, 114688, 0
    s_sub_u32 s34, s34, s26
    s_waitcnt vmcnt(6)
    s_barrier
    s_add_u32 m0, s35, 114688
    s_nop 0
    buffer_load_dwordx4 v2, s[16:19], s34 offen lds
    s_add_u32 m0, s35, 115712
    s_add_u32 s26, s34, 1024
    buffer_load_dwordx4 v2, s[16:19], s26 offen lds
    s_add_u32 s34, s34, 4096
    s_sub_u32 s38, s38, 1
    s_cmp_eq_u32 s38, 0
    s_cselect_b32 s26, 114688, 0
    s_sub_u32 s34, s34, s26
    s_waitcnt vmcnt(6)
    s_barrier
    s_add_u32 m0, s35, 0
    s_nop 0
    buffer_load_dwordx4 v2, s[16:19], s34 offen lds
    s_add_u32 m0, s35, 1024
    s_add_u32 s26, s34, 1024
    buffer_load_dwordx4 v2, s[16:19], s26 offen lds
    s_add_u32 s34, s34, 4096
    s_sub_u32 s38, s38, 1
    s_cmp_eq_u32 s38, 0
    s_cselect_b32 s26, 114688, 0
    s_sub_u32 s34, s34, s26
    s_waitcnt vmcnt(6)
    s_barrier
    s_add_u32 m0, s35, 16384
    s_nop 0
    buffer_load_dwordx4 v2, s[16:19], s34 offen lds
    s_add_u32 m0, s35, 17408
    s_add_u32 s26, s34, 1024
    buffer_load_dwordx4 v2, s[16:19], s26 offen lds
    s_add_u32 s34, s34, 4096
    s_sub_u32 s38, s38, 1
    s_cmp_eq_u32 s38, 0
    s_cselect_b32 s26, 114688, 0
    s_sub_u32 s34, s34, s26
    s_waitcnt vmcnt(6)
    s_barrier
    s_add_u32 m0, s35, 32768
    s_nop 0
    buffer_load_dwordx4 v2, s[16:19], s34 offen lds
    s_add_u32 m0, s35, 33792
    s_add_u32 s26, s34, 1024
    buffer_load_dwordx4 v2, s[16:19], s26 offen lds
    s_add_u32 s34, s34, 4096
    s_sub_u32 s38, s38, 1
    s_cmp_eq_u32 s38, 0
    s_cselect_b32 s26, 114688, 0
    s_sub_u32 s34, s34, s26
    s_waitcnt vmcnt(6)
    s_barrier
    s_add_u32 m0, s35, 49152
    s_nop 0
    buffer_load_dwordx4 v2, s[16:19], s34 offen lds
    s_add_u32 m0, s35, 50176
    s_add_u32 s26, s34, 1024
    buffer_load_dwordx4 v2, s[16:19], s26 offen lds
    s_add_u32 s34, s34, 4096
    s_sub_u32 s38, s38, 1
    s_cmp_eq_u32 s38, 0
    s_cselect_b32 s26, 114688, 0
    s_sub_u32 s34, s34, s26
    s_waitcnt vmcnt(6)
    s_barrier
    s_add_u32 m0, s35, 65536
    s_nop 0
    buffer_load_dwordx4 v2, s[16:19], s34 offen lds
    s_add_u32 m0, s35, 66560
    s_add_u32 s26, s34, 1024
    buffer_load_dwordx4 v2, s[16:19], s26 offen lds
    s_add_u32 s34, s34, 4096
    s_sub_u32 s38, s38, 1
    s_cmp_eq_u32 s38, 0
    s_cselect_b32 s26, 114688, 0
    s_sub_u32 s34, s34, s26
    s_waitcnt vmcnt(6)
    s_barrier
    s_add_u32 m0, s35, 81920
    s_nop 0
    buffer_load_dwordx4 v2, s[16:19], s34 offen lds
    s_add_u32 m0, s35, 82944
    s_add_u32 s26, s34, 1024
    buffer_load_dwordx4 v2, s[16:19], s26 offen lds
    s_add_u32 s34, s34, 4096
    s_sub_u32 s38, s38, 1
    s_cmp_eq_u32 s38, 0
    s_cselect_b32 s26, 114688, 0
    s_sub_u32 s34, s34, s26
    s_waitcnt vmcnt(6)
    s_barrier
    s_add_u32 m0, s35, 98304
    s_nop 0
    buffer_load_dwordx4 v2, s[16:19], s34 offen lds
    s_add_u32 m0, s35, 99328
    s_add_u32 s26, s34, 1024
    buffer_load_dwordx4 v2, s[16:19], s26 offen lds
    s_add_u32 s34, s34, 4096
    s_sub_u32 s38, s38, 1
    s_cmp_eq_u32 s38, 0
    s_cselect_b32 s26, 114688, 0
    s_sub_u32 s34, s34, s26
    s_waitcnt vmcnt(6)
    s_barrier
    s_add_u32 m0, s35, 114688
    s_nop 0
    buffer_load_dwordx4 v2, s[16:19], s34 offen lds
    s_add_u32 m0, s35, 115712
    s_add_u32 s26, s34, 1024
    buffer_load_dwordx4 v2, s[16:19], s26 offen lds
    s_add_u32 s34, s34, 4096
    s_sub_u32 s38, s38, 1
    s_cmp_eq_u32 s38, 0
    s_cselect_b32 s26, 114688, 0
    s_sub_u32 s34, s34, s26
    s_waitcnt vmcnt(6)
    s_barrier
    s_add_u32 m0, s35, 0
    s_nop 0
    buffer_load_dwordx4 v2, s[16:19], s34 offen lds
    s_add_u32 m0, s35, 1024
    s_add_u32 s26, s34, 1024
    buffer_load_dwordx4 v2, s[16:19], s26 offen lds
    s_add_u32 s34, s34, 4096
    s_sub_u32 s38, s38, 1
    s_cmp_eq_u32 s38, 0
    s_cselect_b32 s26, 114688, 0
    s_sub_u32 s34, s34, s26
    s_waitcnt vmcnt(6)
    s_barrier
    s_add_u32 m0, s35, 16384
    s_nop 0
    buffer_load_dwordx4 v2, s[16:19], s34 offen lds
    s_add_u32 m0, s35, 17408
    s_add_u32 s26, s34, 1024
    buffer_load_dwordx4 v2, s[16:19], s26 offen lds
    s_add_u32 s34, s34, 4096
    s_sub_u32 s38, s38, 1
    s_cmp_eq_u32 s38, 0
    s_cselect_b32 s26, 114688, 0
    s_sub_u32 s34, s34, s26
    s_waitcnt vmcnt(6)
    s_barrier
    s_add_u32 m0, s35, 32768
    s_nop 0
    buffer_load_dwordx4 v2, s[16:19], s34 offen lds
    s_add_u32 m0, s35, 33792
    s_add_u32 s26, s34, 1024
    buffer_load_dwordx4 v2, s[16:19], s26 offen lds
    s_add_u32 s34, s34, 4096
    s_sub_u32 s38, s38, 1
    s_cmp_eq_u32 s38, 0
    s_cselect_b32 s26, 114688, 0
    s_sub_u32 s34, s34, s26
    s_waitcnt vmcnt(6)
    s_barrier
    s_add_u32 m0, s35, 49152
    s_nop 0
    buffer_load_dwordx4 v2, s[16:19], s34 offen lds
    s_add_u32 m0, s35, 50176
    s_add_u32 s26, s34, 1024
    buffer_load_dwordx4 v2, s[16:19], s26 offen lds
    s_add_u32 s34, s34, 4096
    s_sub_u32 s38, s38, 1
    s_cmp_eq_u32 s38, 0
    s_cselect_b32 s26, 114688, 0
    s_sub_u32 s34, s34, s26
    s_waitcnt vmcnt(6)
    s_barrier
    s_waitcnt vmcnt(4)
    s_barrier
    s_waitcnt vmcnt(2)
    s_barrier
    s_waitcnt vmcnt(0)
    s_barrier
    s_endpgm
mlp2_kernel_wprod:
    s_sub_u32 s23, s22, 8
    v_lshrrev_b32 v3, 3, v1
    v_and_b32 v4, 7, v1
    v_bfe_u32 v5, v1, 4, 1
    v_lshlrev_b32 v5, 2, v5
    v_xor_b32 v4, v4, v5
    v_lshlrev_b32 v4, 4, v4
    s_mov_b32 s26, 1024
    v_mul_lo_u32 v3, v3, s26
    v_add_u32 v3, v3, v4
    s_mul_i32 s36, s23, 16384
    s_add_u32 s36, s36, s32
    s_mul_i32 s37, s23, 2048
    s_add_u32 s37, s37, 8192
    s_mul_i32 s39, s29, 65536
    s_add_u32 s36, s36, s39
    s_sub_u32 s38, 28, s29
    s_waitcnt lgkmcnt(0)
    s_mov_b32 s8, s4
    s_mov_b32 s9, s5
    s_mov_b32 s10, 1835008
    s_mov_b32 s11, 0x00020000
    s_add_u32 m0, s37, 0
    s_nop 0
    buffer_load_dwordx4 v3, s[8:11], s36 offen lds
    s_add_u32 m0, s37, 1024
    s_add_u32 s26, s36, 8192
    buffer_load_dwordx4 v3, s[8:11], s26 offen lds
    s_add_u32 s36, s36, 65536
    s_sub_u32 s38, s38, 1
    s_cmp_eq_u32 s38, 0
    s_cselect_b32 s27, 1835008, 0
    s_sub_u32 s36, s36, s27
    s_add_u32 m0, s37, 16384
    s_nop 0
    buffer_load_dwordx4 v3, s[8:11], s36 offen lds
    s_add_u32 m0, s37, 17408
    s_add_u32 s26, s36, 8192
    buffer_load_dwordx4 v3, s[8:11], s26 offen lds
    s_add_u32 s36, s36, 65536
    s_sub_u32 s38, s38, 1
    s_cmp_eq_u32 s38, 0
    s_cselect_b32 s27, 1835008, 0
    s_sub_u32 s36, s36, s27
    s_add_u32 m0, s37, 32768
    s_nop 0
    buffer_load_dwordx4 v3, s[8:11], s36 offen lds
    s_add_u32 m0, s37, 33792
    s_add_u32 s26, s36, 8192
    buffer_load_dwordx4 v3, s[8:11], s26 offen lds
    s_add_u32 s36, s36, 65536
    s_sub_u32 s38, s38, 1
    s_cmp_eq_u32 s38, 0
    s_cselect_b32 s27, 1835008, 0
    s_sub_u32 s36, s36, s27
    s_add_u32 m0, s37, 49152
    s_nop 0
    buffer_load_dwordx4 v3, s[8:11], s36 offen lds
    s_add_u32 m0, s37, 50176
    s_add_u32 s26, s36, 8192
    buffer_load_dwordx4 v3, s[8:11], s26 offen lds
    s_add_u32 s36, s36, 65536
    s_sub_u32 s38, s38, 1
    s_cmp_eq_u32 s38, 0
    s_cselect_b32 s27, 1835008, 0
    s_sub_u32 s36, s36, s27
    s_waitcnt vmcnt(6)
    s_barrier
    s_add_u32 m0, s37, 65536
    s_nop 0
    buffer_load_dwordx4 v3, s[8:11], s36 offen lds
    s_add_u32 m0, s37, 66560
    s_add_u32 s26, s36, 8192
    buffer_load_dwordx4 v3, s[8:11], s26 offen lds
    s_add_u32 s36, s36, 65536
    s_sub_u32 s38, s38, 1
    s_cmp_eq_u32 s38, 0
    s_cselect_b32 s27, 1835008, 0
    s_sub_u32 s36, s36, s27
    s_waitcnt vmcnt(6)
    s_barrier
    s_add_u32 m0, s37, 81920
    s_nop 0
    buffer_load_dwordx4 v3, s[8:11], s36 offen lds
    s_add_u32 m0, s37, 82944
    s_add_u32 s26, s36, 8192
    buffer_load_dwordx4 v3, s[8:11], s26 offen lds
    s_add_u32 s36, s36, 65536
    s_sub_u32 s38, s38, 1
    s_cmp_eq_u32 s38, 0
    s_cselect_b32 s27, 1835008, 0
    s_sub_u32 s36, s36, s27
    s_waitcnt vmcnt(6)
    s_barrier
    s_add_u32 m0, s37, 98304
    s_nop 0
    buffer_load_dwordx4 v3, s[8:11], s36 offen lds
    s_add_u32 m0, s37, 99328
    s_add_u32 s26, s36, 8192
    buffer_load_dwordx4 v3, s[8:11], s26 offen lds
    s_add_u32 s36, s36, 65536
    s_sub_u32 s38, s38, 1
    s_cmp_eq_u32 s38, 0
    s_cselect_b32 s27, 1835008, 0
    s_sub_u32 s36, s36, s27
    s_waitcnt vmcnt(6)
    s_barrier
    s_add_u32 m0, s37, 114688
    s_nop 0
    buffer_load_dwordx4 v3, s[8:11], s36 offen lds
    s_add_u32 m0, s37, 115712
    s_add_u32 s26, s36, 8192
    buffer_load_dwordx4 v3, s[8:11], s26 offen lds
    s_add_u32 s36, s36, 65536
    s_sub_u32 s38, s38, 1
    s_cmp_eq_u32 s38, 0
    s_cselect_b32 s27, 1835008, 0
    s_sub_u32 s36, s36, s27
    s_waitcnt vmcnt(6)
    s_barrier
    s_add_u32 m0, s37, 0
    s_nop 0
    buffer_load_dwordx4 v3, s[8:11], s36 offen lds
    s_add_u32 m0, s37, 1024
    s_add_u32 s26, s36, 8192
    buffer_load_dwordx4 v3, s[8:11], s26 offen lds
    s_add_u32 s36, s36, 65536
    s_sub_u32 s38, s38, 1
    s_cmp_eq_u32 s38, 0
    s_cselect_b32 s27, 1835008, 0
    s_sub_u32 s36, s36, s27
    s_waitcnt vmcnt(6)
    s_barrier
    s_add_u32 m0, s37, 16384
    s_nop 0
    buffer_load_dwordx4 v3, s[8:11], s36 offen lds
    s_add_u32 m0, s37, 17408
    s_add_u32 s26, s36, 8192
    buffer_load_dwordx4 v3, s[8:11], s26 offen lds
    s_add_u32 s36, s36, 65536
    s_sub_u32 s38, s38, 1
    s_cmp_eq_u32 s38, 0
    s_cselect_b32 s27, 1835008, 0
    s_sub_u32 s36, s36, s27
    s_waitcnt vmcnt(6)
    s_barrier
    s_add_u32 m0, s37, 32768
    s_nop 0
    buffer_load_dwordx4 v3, s[8:11], s36 offen lds
    s_add_u32 m0, s37, 33792
    s_add_u32 s26, s36, 8192
    buffer_load_dwordx4 v3, s[8:11], s26 offen lds
    s_add_u32 s36, s36, 65536
    s_sub_u32 s38, s38, 1
    s_cmp_eq_u32 s38, 0
    s_cselect_b32 s27, 1835008, 0
    s_sub_u32 s36, s36, s27
    s_waitcnt vmcnt(6)
    s_barrier
    s_add_u32 m0, s37, 49152
    s_nop 0
    buffer_load_dwordx4 v3, s[8:11], s36 offen lds
    s_add_u32 m0, s37, 50176
    s_add_u32 s26, s36, 8192
    buffer_load_dwordx4 v3, s[8:11], s26 offen lds
    s_add_u32 s36, s36, 65536
    s_sub_u32 s38, s38, 1
    s_cmp_eq_u32 s38, 0
    s_cselect_b32 s27, 1835008, 0
    s_sub_u32 s36, s36, s27
    s_waitcnt vmcnt(6)
    s_barrier
    s_add_u32 m0, s37, 65536
    s_nop 0
    buffer_load_dwordx4 v3, s[8:11], s36 offen lds
    s_add_u32 m0, s37, 66560
    s_add_u32 s26, s36, 8192
    buffer_load_dwordx4 v3, s[8:11], s26 offen lds
    s_add_u32 s36, s36, 65536
    s_sub_u32 s38, s38, 1
    s_cmp_eq_u32 s38, 0
    s_cselect_b32 s27, 1835008, 0
    s_sub_u32 s36, s36, s27
    s_waitcnt vmcnt(6)
    s_barrier
    s_add_u32 m0, s37, 81920
    s_nop 0
    buffer_load_dwordx4 v3, s[8:11], s36 offen lds
    s_add_u32 m0, s37, 82944
    s_add_u32 s26, s36, 8192
    buffer_load_dwordx4 v3, s[8:11], s26 offen lds
    s_add_u32 s36, s36, 65536
    s_sub_u32 s38, s38, 1
    s_cmp_eq_u32 s38, 0
    s_cselect_b32 s27, 1835008, 0
    s_sub_u32 s36, s36, s27
    s_waitcnt vmcnt(6)
    s_barrier
    s_add_u32 m0, s37, 98304
    s_nop 0
    buffer_load_dwordx4 v3, s[8:11], s36 offen lds
    s_add_u32 m0, s37, 99328
    s_add_u32 s26, s36, 8192
    buffer_load_dwordx4 v3, s[8:11], s26 offen lds
    s_add_u32 s36, s36, 65536
    s_sub_u32 s38, s38, 1
    s_cmp_eq_u32 s38, 0
    s_cselect_b32 s27, 1835008, 0
    s_sub_u32 s36, s36, s27
    s_waitcnt vmcnt(6)
    s_barrier
    s_add_u32 m0, s37, 114688
    s_nop 0
    buffer_load_dwordx4 v3, s[8:11], s36 offen lds
    s_add_u32 m0, s37, 115712
    s_add_u32 s26, s36, 8192
    buffer_load_dwordx4 v3, s[8:11], s26 offen lds
    s_add_u32 s36, s36, 65536
    s_sub_u32 s38, s38, 1
    s_cmp_eq_u32 s38, 0
    s_cselect_b32 s27, 1835008, 0
    s_sub_u32 s36, s36, s27
    s_waitcnt vmcnt(6)
    s_barrier
    s_add_u32 m0, s37, 0
    s_nop 0
    buffer_load_dwordx4 v3, s[8:11], s36 offen lds
    s_add_u32 m0, s37, 1024
    s_add_u32 s26, s36, 8192
    buffer_load_dwordx4 v3, s[8:11], s26 offen lds
    s_add_u32 s36, s36, 65536
    s_sub_u32 s38, s38, 1
    s_cmp_eq_u32 s38, 0
    s_cselect_b32 s27, 1835008, 0
    s_sub_u32 s36, s36, s27
    s_waitcnt vmcnt(6)
    s_barrier
    s_add_u32 m0, s37, 16384
    s_nop 0
    buffer_load_dwordx4 v3, s[8:11], s36 offen lds
    s_add_u32 m0, s37, 17408
    s_add_u32 s26, s36, 8192
    buffer_load_dwordx4 v3, s[8:11], s26 offen lds
    s_add_u32 s36, s36, 65536
    s_sub_u32 s38, s38, 1
    s_cmp_eq_u32 s38, 0
    s_cselect_b32 s27, 1835008, 0
    s_sub_u32 s36, s36, s27
    s_waitcnt vmcnt(6)
    s_barrier
    s_add_u32 m0, s37, 32768
    s_nop 0
    buffer_load_dwordx4 v3, s[8:11], s36 offen lds
    s_add_u32 m0, s37, 33792
    s_add_u32 s26, s36, 8192
    buffer_load_dwordx4 v3, s[8:11], s26 offen lds
    s_add_u32 s36, s36, 65536
    s_sub_u32 s38, s38, 1
    s_cmp_eq_u32 s38, 0
    s_cselect_b32 s27, 1835008, 0
    s_sub_u32 s36, s36, s27
    s_waitcnt vmcnt(6)
    s_barrier
    s_add_u32 m0, s37, 49152
    s_nop 0
    buffer_load_dwordx4 v3, s[8:11], s36 offen lds
    s_add_u32 m0, s37, 50176
    s_add_u32 s26, s36, 8192
    buffer_load_dwordx4 v3, s[8:11], s26 offen lds
    s_add_u32 s36, s36, 65536
    s_sub_u32 s38, s38, 1
    s_cmp_eq_u32 s38, 0
    s_cselect_b32 s27, 1835008, 0
    s_sub_u32 s36, s36, s27
    s_waitcnt vmcnt(6)
    s_barrier
    s_add_u32 m0, s37, 65536
    s_nop 0
    buffer_load_dwordx4 v3, s[8:11], s36 offen lds
    s_add_u32 m0, s37, 66560
    s_add_u32 s26, s36, 8192
    buffer_load_dwordx4 v3, s[8:11], s26 offen lds
    s_add_u32 s36, s36, 65536
    s_sub_u32 s38, s38, 1
    s_cmp_eq_u32 s38, 0
    s_cselect_b32 s27, 1835008, 0
    s_sub_u32 s36, s36, s27
    s_waitcnt vmcnt(6)
    s_barrier
    s_add_u32 m0, s37, 81920
    s_nop 0
    buffer_load_dwordx4 v3, s[8:11], s36 offen lds
    s_add_u32 m0, s37, 82944
    s_add_u32 s26, s36, 8192
    buffer_load_dwordx4 v3, s[8:11], s26 offen lds
    s_add_u32 s36, s36, 65536
    s_sub_u32 s38, s38, 1
    s_cmp_eq_u32 s38, 0
    s_cselect_b32 s27, 1835008, 0
    s_sub_u32 s36, s36, s27
    s_waitcnt vmcnt(6)
    s_barrier
    s_add_u32 m0, s37, 98304
    s_nop 0
    buffer_load_dwordx4 v3, s[8:11], s36 offen lds
    s_add_u32 m0, s37, 99328
    s_add_u32 s26, s36, 8192
    buffer_load_dwordx4 v3, s[8:11], s26 offen lds
    s_add_u32 s36, s36, 65536
    s_sub_u32 s38, s38, 1
    s_cmp_eq_u32 s38, 0
    s_cselect_b32 s27, 1835008, 0
    s_sub_u32 s36, s36, s27
    s_waitcnt vmcnt(6)
    s_barrier
    s_add_u32 m0, s37, 114688
    s_nop 0
    buffer_load_dwordx4 v3, s[8:11], s36 offen lds
    s_add_u32 m0, s37, 115712
    s_add_u32 s26, s36, 8192
    buffer_load_dwordx4 v3, s[8:11], s26 offen lds
    s_add_u32 s36, s36, 65536
    s_sub_u32 s38, s38, 1
    s_cmp_eq_u32 s38, 0
    s_cselect_b32 s27, 1835008, 0
    s_sub_u32 s36, s36, s27
    s_waitcnt vmcnt(6)
    s_barrier
    s_add_u32 m0, s37, 0
    s_nop 0
    buffer_load_dwordx4 v3, s[8:11], s36 offen lds
    s_add_u32 m0, s37, 1024
    s_add_u32 s26, s36, 8192
    buffer_load_dwordx4 v3, s[8:11], s26 offen lds
    s_add_u32 s36, s36, 65536
    s_sub_u32 s38, s38, 1
    s_cmp_eq_u32 s38, 0
    s_cselect_b32 s27, 1835008, 0
    s_sub_u32 s36, s36, s27
    s_waitcnt vmcnt(6)
    s_barrier
    s_add_u32 m0, s37, 16384
    s_nop 0
    buffer_load_dwordx4 v3, s[8:11], s36 offen lds
    s_add_u32 m0, s37, 17408
    s_add_u32 s26, s36, 8192
    buffer_load_dwordx4 v3, s[8:11], s26 offen lds
    s_add_u32 s36, s36, 65536
    s_sub_u32 s38, s38, 1
    s_cmp_eq_u32 s38, 0
    s_cselect_b32 s27, 1835008, 0
    s_sub_u32 s36, s36, s27
    s_waitcnt vmcnt(6)
    s_barrier
    s_add_u32 m0, s37, 32768
    s_nop 0
    buffer_load_dwordx4 v3, s[8:11], s36 offen lds
    s_add_u32 m0, s37, 33792
    s_add_u32 s26, s36, 8192
    buffer_load_dwordx4 v3, s[8:11], s26 offen lds
    s_add_u32 s36, s36, 65536
    s_sub_u32 s38, s38, 1
    s_cmp_eq_u32 s38, 0
    s_cselect_b32 s27, 1835008, 0
    s_sub_u32 s36, s36, s27
    s_waitcnt vmcnt(6)
    s_barrier
    s_add_u32 m0, s37, 49152
    s_nop 0
    buffer_load_dwordx4 v3, s[8:11], s36 offen lds
    s_add_u32 m0, s37, 50176
    s_add_u32 s26, s36, 8192
    buffer_load_dwordx4 v3, s[8:11], s26 offen lds
    s_add_u32 s36, s36, 65536
    s_sub_u32 s38, s38, 1
    s_cmp_eq_u32 s38, 0
    s_cselect_b32 s27, 1835008, 0
    s_sub_u32 s36, s36, s27
    s_waitcnt vmcnt(6)
    s_barrier
    s_waitcnt vmcnt(4)
    s_barrier
    s_waitcnt vmcnt(2)
    s_barrier
    s_waitcnt vmcnt(0)
    s_barrier
    s_endpgm
mlp2_kernel_cons:
    s_lshr_b32 s23, s22, 1
    s_and_b32 s24, s22, 1
    v_and_b32 v3, 31, v1
    v_lshrrev_b32 v4, 5, v1
    v_lshlrev_b32 v2, 4, v1
    s_lshl_b32 s27, s20, 1
    s_add_u32 s27, s27, s23
    s_waitcnt lgkmcnt(0)
    s_mov_b32 s18, 18874368
    s_mov_b32 s19, 0x00020000
    s_mov_b32 s12, s40
    s_mov_b32 s13, s41
    s_mov_b32 s14, 1024
    s_mov_b32 s15, 0x00020000
    s_mov_b32 s44, s42
    s_mov_b32 s45, s43
    s_mov_b32 s46, 2097152
    s_mov_b32 s47, 0x00020000
    s_lshl_b32 s28, s27, 15
    s_lshl_b32 s26, s21, 12
    s_add_u32 s28, s28, s26
    s_lshl_b32 s26, s24, 11
    s_add_u32 s28, s28, s26
    s_add_u32 s28, s28, 8388608
    buffer_load_dwordx4 v[96:99], v2, s[16:19], s28 offen
    buffer_load_dwordx4 v[100:103], v2, s[16:19], s28 offen offset:1024
    v_lshlrev_b32 v5, 3, v4
    s_lshl_b32 s28, s21, 7
    s_lshl_b32 s26, s24, 6
    s_add_u32 s28, s28, s26
    buffer_load_dwordx2 v[104:105], v5, s[12:15], s28 offen offset:0
    buffer_load_dwordx2 v[106:107], v5, s[12:15], s28 offen offset:16
    buffer_load_dwordx2 v[108:109], v5, s[12:15], s28 offen offset:32
    buffer_load_dwordx2 v[110:111], v5, s[12:15], s28 offen offset:48
    v_lshrrev_b32 v4, 5, v1
    v_lshlrev_b32 v5, 4, v1
    s_mul_i32 s26, s23, 4096
    v_add_u32 v14, s26, v5
    v_bfe_u32 v7, v1, 2, 2
    v_lshl_add_u32 v8, v4, 2, v7
    v_mul_u32_u24 v8, 128, v8
    v_lshrrev_b32 v7, 1, v7
    v_lshl_add_u32 v8, v7, 6, v8
    v_bfe_u32 v7, v1, 4, 1
    v_lshl_add_u32 v8, v7, 5, v8
    v_and_b32 v7, 3, v1
    v_lshl_add_u32 v8, v7, 3, v8
    v_add_u32 v8, 8192, v8
    s_lshl_b32 s26, s24, 6
    v_xor_b32 v15, s26, v8
    v_mov_b32 v16, v14
    v_mov_b32 v17, v15
    v_mov_b32 v18, v16
    v_mov_b32 v19, v17
    v_mov_b32 v56, 0
    v_mov_b32 v57, 0
    v_mov_b32 v58, 0
    v_mov_b32 v59, 0
    v_mov_b32 v60, 0
    v_mov_b32 v61, 0
    v_mov_b32 v62, 0
    v_mov_b32 v63, 0
    v_mov_b32 v64, 0
    v_mov_b32 v65, 0
    v_mov_b32 v66, 0
    v_mov_b32 v67, 0
    v_mov_b32 v68, 0
    v_mov_b32 v69, 0
    v_mov_b32 v70, 0
    v_mov_b32 v71, 0
    s_mov_b32 s34, 0
    s_mov_b32 s35, 0
    s_barrier
    ds_read_b128 v[24:27], v18 offset:0
    ds_read_b64_tr_b16 v[28:29], v19 offset:0
    ds_read_b64_tr_b16 v[30:31], v19 offset:1024
    ds_read_b128 v[32:35], v18 offset:1024
    ds_read_b64_tr_b16 v[36:37], v19 offset:2048
    ds_read_b64_tr_b16 v[38:39], v19 offset:3072
    ds_read_b128 v[40:43], v18 offset:2048
    ds_read_b64_tr_b16 v[44:45], v19 offset:4096
    ds_read_b64_tr_b16 v[46:47], v19 offset:5120
    ds_read_b128 v[48:51], v18 offset:3072
    ds_read_b64_tr_b16 v[52:53], v19 offset:6144
    ds_read_b64_tr_b16 v[54:55], v19 offset:7168
mlp2_kernel_var0:
mlp2_kernel_loop0:
    s_add_u32 s34, s34, 16384
    s_cmp_eq_u32 s34, 131072
    s_cselect_b32 s34, 0, s34
    v_add_u32 v20, s34, v16
    v_add_u32 v21, s34, v17
    s_barrier
    s_waitcnt lgkmcnt(9)
    v_mfma_f32_32x32x16_bf16 v[56:71], v[28:31], v[24:27], v[56:71]
    ds_read_b64_tr_b16 v[28:29], v21 offset:0
    ds_read_b64_tr_b16 v[30:31], v21 offset:1024
    ds_read_b128 v[24:27], v20 offset:0
    s_waitcnt lgkmcnt(9)
    v_mfma_f32_32x32x16_bf16 v[56:71], v[36:39], v[32:35], v[56:71]
    ds_read_b64_tr_b16 v[36:37], v21 offset:2048
    ds_read_b64_tr_b16 v[38:39], v21 offset:3072
    ds_read_b128 v[32:35], v20 offset:1024
    s_waitcnt lgkmcnt(9)
    v_mfma_f32_32x32x16_bf16 v[56:71], v[44:47], v[40:43], v[56:71]
    ds_read_b64_tr_b16 v[44:45], v21 offset:4096
    ds_read_b64_tr_b16 v[46:47], v21 offset:5120
    ds_read_b128 v[40:43], v20 offset:2048
    s_waitcnt lgkmcnt(9)
    v_mfma_f32_32x32x16_bf16 v[56:71], v[52:55], v[48:51], v[56:71]
    ds_read_b64_tr_b16 v[52:53], v21 offset:6144
    ds_read_b64_tr_b16 v[54:55], v21 offset:7168
    ds_read_b128 v[48:51], v20 offset:3072
    v_mov_b32 v18, v20
    v_mov_b32 v19, v21
    s_add_u32 s35, s35, 1
    s_cmp_lt_u32 s35, 27
    s_cbranch_scc1 mlp2_kernel_loop0
    s_waitcnt lgkmcnt(9)
    v_mfma_f32_32x32x16_bf16 v[56:71], v[28:31], v[24:27], v[56:71]
    s_waitcnt lgkmcnt(6)
    v_mfma_f32_32x32x16_bf16 v[56:71], v[36:39], v[32:35], v[56:71]
    s_waitcnt lgkmcnt(3)
    v_mfma_f32_32x32x16_bf16 v[56:71], v[44:47], v[40:43], v[56:71]
    s_waitcnt lgkmcnt(0)
    v_mfma_f32_32x32x16_bf16 v[56:71], v[52:55], v[48:51], v[56:71]
mlp2_kernel_epi:
    s_waitcnt vmcnt(0)
    s_nop 11
    v_lshlrev_b32 v112, 16, v96
    v_and_b32 v113, 0xffff0000, v96
    v_lshlrev_b32 v114, 16, v104
    v_and_b32 v115, 0xffff0000, v104
    v_add_f32 v56, v56, v114
    v_add_f32 v57, v57, v115
    v_add_f32 v56, v56, v112
    v_add_f32 v57, v57, v113
    v_lshlrev_b32 v112, 16, v97
    v_and_b32 v113, 0xffff0000, v97
    v_lshlrev_b32 v114, 16, v105
    v_and_b32 v115, 0xffff0000, v105
    v_add_f32 v58, v58, v114
    v_add_f32 v59, v59, v115
    v_add_f32 v58, v58, v112
    v_add_f32 v59, v59, v113
    v_lshlrev_b32 v112, 16, v98
    v_and_b32 v113, 0xffff0000, v98
    v_lshlrev_b32 v114, 16, v106
    v_and_b32 v115, 0xffff0000, v106
    v_add_f32 v60, v60, v114
    v_add_f32 v61, v61, v115
    v_add_f32 v60, v60, v112
    v_add_f32 v61, v61, v113
    v_lshlrev_b32 v112, 16, v99
    v_and_b32 v113, 0xffff0000, v99
    v_lshlrev_b32 v114, 16, v107
    v_and_b32 v115, 0xffff0000, v107
    v_add_f32 v62, v62, v114
    v_add_f32 v63, v63, v115
    v_add_f32 v62, v62, v112
    v_add_f32 v63, v63, v113
    v_lshlrev_b32 v112, 16, v100
    v_and_b32 v113, 0xffff0000, v100
    v_lshlrev_b32 v114, 16, v108
    v_and_b32 v115, 0xffff0000, v108
    v_add_f32 v64, v64, v114
    v_add_f32 v65, v65, v115
    v_add_f32 v64, v64, v112
    v_add_f32 v65, v65, v113
    v_lshlrev_b32 v112, 16, v101
    v_and_b32 v113, 0xffff0000, v101
    v_lshlrev_b32 v114, 16, v109
    v_and_b32 v115, 0xffff0000, v109
    v_add_f32 v66, v66, v114
    v_add_f32 v67, v67, v115
    v_add_f32 v66, v66, v112
    v_add_f32 v67, v67, v113
    v_lshlrev_b32 v112, 16, v102
    v_and_b32 v113, 0xffff0000, v102
    v_lshlrev_b32 v114, 16, v110
    v_and_b32 v115, 0xffff0000, v110
    v_add_f32 v68, v68, v114
    v_add_f32 v69, v69, v115
    v_add_f32 v68, v68, v112
    v_add_f32 v69, v69, v113
    v_lshlrev_b32 v112, 16, v103
    v_and_b32 v113, 0xffff0000, v103
    v_lshlrev_b32 v114, 16, v111
    v_and_b32 v115, 0xffff0000, v111
    v_add_f32 v70, v70, v114
    v_add_f32 v71, v71, v115
    v_add_f32 v70, v70, v112
    v_add_f32 v71, v71, v113
    v_cvt_pk_bf16_f32 v116, v56, v57
    v_cvt_pk_bf16_f32 v117, v58, v59
    v_cvt_pk_bf16_f32 v118, v60, v61
    v_cvt_pk_bf16_f32 v119, v62, v63
    v_cvt_pk_bf16_f32 v120, v64, v65
    v_cvt_pk_bf16_f32 v121, v66, v67
    v_cvt_pk_bf16_f32 v122, v68, v69
    v_cvt_pk_bf16_f32 v123, v70, v71
    v_lshlrev_b32 v5, 10, v3
    v_lshl_add_u32 v5, v4, 4, v5
    v_permlane32_swap_b32 v116, v118
    v_permlane32_swap_b32 v117, v119
    v_permlane32_swap_b32 v120, v122
    v_permlane32_swap_b32 v121, v123
    s_lshl_b32 s28, s27, 15
    s_lshl_b32 s26, s21, 7
    s_add_u32 s28, s28, s26
    s_lshl_b32 s26, s24, 6
    s_add_u32 s28, s28, s26
    buffer_store_dwordx4 v[116:119], v5, s[44:47], s28 offen
    buffer_store_dwordx4 v[120:123], v5, s[44:47], s28 offen offset:32
mlp2_kernel_done:
    s_endpgm
mlp2_kernel_end:
.section .rodata,"a"
.p2align 6
.amdhsa_kernel qkv_kernel
  .amdhsa_next_free_vgpr 128
  .amdhsa_next_free_sgpr 96
  .amdhsa_accum_offset 128
  .amdhsa_group_segment_fixed_size 0
  .amdhsa_kernarg_size 88
  .amdhsa_user_sgpr_count 2
  .amdhsa_user_sgpr_kernarg_segment_ptr 1
  .amdhsa_system_sgpr_workgroup_id_x 1
.end_amdhsa_kernel
.amdhsa_kernel att_kernel
  .amdhsa_next_free_vgpr 128
  .amdhsa_next_free_sgpr 96
  .amdhsa_accum_offset 128
  .amdhsa_group_segment_fixed_size 0
  .amdhsa_kernarg_size 88
  .amdhsa_user_sgpr_count 2
  .amdhsa_user_sgpr_kernarg_segment_ptr 1
  .amdhsa_system_sgpr_workgroup_id_x 1
.end_amdhsa_kernel
.amdhsa_kernel wo_kernel
  .amdhsa_next_free_vgpr 128
  .amdhsa_next_free_sgpr 96
  .amdhsa_accum_offset 128
  .amdhsa_group_segment_fixed_size 0
  .amdhsa_kernarg_size 88
  .amdhsa_user_sgpr_count 2
  .amdhsa_user_sgpr_kernarg_segment_ptr 1
  .amdhsa_system_sgpr_workgroup_id_x 1
.end_amdhsa_kernel
.amdhsa_kernel mlp1_kernel
  .amdhsa_next_free_vgpr 128
  .amdhsa_next_free_sgpr 96
  .amdhsa_accum_offset 128
  .amdhsa_group_segment_fixed_size 0
  .amdhsa_kernarg_size 88
  .amdhsa_user_sgpr_count 2
  .amdhsa_user_sgpr_kernarg_segment_ptr 1
  .amdhsa_system_sgpr_workgroup_id_x 1
.end_amdhsa_kernel
.amdhsa_kernel mlp2_kernel
  .amdhsa_next_free_vgpr 128
  .amdhsa_next_free_sgpr 96
  .amdhsa_accum_offset 128
  .amdhsa_group_segment_fixed_size 0
  .amdhsa_kernarg_size 88
  .amdhsa_user_sgpr_count 2
  .amdhsa_user_sgpr_kernarg_segment_ptr 1
  .amdhsa_system_sgpr_workgroup_id_x 1
.end_amdhsa_kernel
```
